```python
import torch

def _softmax(x, axis=-1):
    return torch.softmax(x, dim=axis)
def _gelu(x):
    return torch.nn.functional.gelu(x, approximate="tanh")
def _silu(x):
    return torch.nn.functional.silu(x)
def _sigmoid(x):
    return torch.sigmoid(x)
def _layernorm(x, axis=-1, eps=1e-5):
    m = x.mean(dim=axis, keepdim=True)
    v = x.var(dim=axis, keepdim=True, unbiased=False)
    return (x - m) / torch.sqrt(v + eps)
def _scatter_add(tgt, idx, src, axis=0):
    return tgt.clone().index_add_(axis, idx, src)
def _segment_sum(src, seg, n):
    out = torch.zeros((n,) + src.shape[1:], dtype=src.dtype)
    return out.index_add_(0, seg, src)
def _pad(x, pw):
    flat = tuple(v for pair in reversed(pw) for v in pair)
    return torch.nn.functional.pad(x, flat)

kernel_name = 'parallel_sum__ssm_conv_h3__mixer_token_mlp__prompt'

def setup_inputs():

    _w = (lambda a: (lambda t: t.to(torch.bfloat16) if t.is_floating_point() else t)(torch.as_tensor(a)))
    def _A_setup():
        B, S, D = 1, 2048, 640
        ks = 4
        return {
            "q": _w((lambda *s: torch.randn(*s, dtype=torch.bfloat16) * 0.05)(B, S, D)),
            "k": _w((lambda *s: torch.randn(*s, dtype=torch.bfloat16) * 0.2)(B, S, D)),
            "v": _w((lambda *s: torch.randn(*s, dtype=torch.bfloat16) * 0.2)(B, S, D)),
            "shift_k": _w((lambda *s: torch.randn(*s, dtype=torch.bfloat16) * 0.2)(D, ks) * 0.5),
            "ssm_k": _w((lambda *s: torch.randn(*s, dtype=torch.bfloat16) * 0.2)(D, S) * (1.0 / S ** 0.5)),
            "ssm_D": _w((lambda *s: torch.randn(*s, dtype=torch.bfloat16) * 0.2)(D)),
        }
    _A_in = _A_setup()

    def _B_setup():
        B, S, D, F = 1, 2048, 640, 1536
        return {
            "x": _w((lambda *s: torch.randn(*s, dtype=torch.bfloat16) * 0.05)(B, S, D)),
            "w1": _w((lambda *s: torch.randn(*s, dtype=torch.bfloat16) * 0.4)(S, F) * (S ** -0.5)),
            "b1": _w((lambda *s: torch.randn(*s, dtype=torch.bfloat16) * 3.2)(F) * 0.02),
            "w2": _w((lambda *s: torch.randn(*s, dtype=torch.bfloat16) * 0.1)(F, S) * (F ** -0.5)),
            "b2": _w((lambda *s: torch.randn(*s, dtype=torch.bfloat16) * 0.4)(S) * 0.02),
        }
    _B_in = _B_setup()

    return {
        "A_q": _A_in["q"],
        "A_k": _A_in["k"],
        "A_v": _A_in["v"],
        "A_shift_k": _A_in["shift_k"],
        "A_ssm_k": _A_in["ssm_k"],
        "A_ssm_D": _A_in["ssm_D"],
        "B_x": _B_in["x"],
        "B_w1": _B_in["w1"],
        "B_b1": _B_in["b1"],
        "B_w2": _B_in["w2"],
        "B_b2": _B_in["b2"],
    }

def reference(A_q, A_k, A_v, A_shift_k, A_ssm_k, A_ssm_D, B_x, B_w1, B_b1, B_w2, B_b2):
    def _A_ref(q, k, v, shift_k, ssm_k, ssm_D):
        B, S, D = q.shape
        ks = shift_k.shape[-1]
        k_pad = _pad(k, ((0, 0), (ks - 1, 0), (0, 0)))
        k_shift = torch.zeros_like(k)
        for t in range(ks):
            k_shift = k_shift + k_pad[:, t:t + S, :] * shift_k[:, ks - 1 - t][None, None, :]
        kv = k_shift * v
        L = 2 * S
        kv_pad = _pad(kv, ((0, 0), (0, S), (0, 0)))
        kf_pad = _pad(ssm_k, ((0, 0), (0, S)))
        kv_f = (lambda x, axes=(-2,-1): torch.fft.rfft2(x.float(), dim=axes))(kv_pad[:, None, :, :], axes=(1, 2))
        kf_f = (lambda x, axes=(-2,-1): torch.fft.rfft2(x.float(), dim=axes))(kf_pad[:, None, :], axes=(1, 2))
        kf_f = (lambda x, *d: x.permute(*d))(kf_f, 1, 2, 0)
        y_f = kv_f * kf_f[None, :, :, :]
        y = (lambda x, s, axes=(-2,-1): torch.fft.irfft2(x, s=s, dim=axes).to(torch.bfloat16))(y_f, (1, L), axes=(1, 2))[:, 0, :S, :]
        y = y + kv * ssm_D[None, None, :]
        return q * y

    def _B_ref(x, w1, b1, w2, b2):
        B, S, D = x.shape
        h = _layernorm(x, axis=-1)
        u = torch.einsum("bsd,sf->bdf", h, w1) + b1
        u = _gelu(u)
        y = torch.einsum("bdf,fs->bds", u, w2) + b2
        return (lambda x, *d: x.permute(*d))(y, 0, 2, 1)

    x = A_q
    xn = _layernorm(x, axis=-1)
    return x + _A_ref(xn, A_k, A_v, A_shift_k, A_ssm_k, A_ssm_D) + _B_ref(xn, B_w1, B_b1, B_w2, B_b2)
```

```asm
; @launch grid=(256,1,1) block=(512,1,1) lds=163200
.amdgcn_target "amdgcn-amd-amdhsa--gfx950"
.text
.globl parallel_sum__ssm_conv_h3__mixer_token_mlp__prompt_kernel
.p2align 8
.type parallel_sum__ssm_conv_h3__mixer_token_mlp__prompt_kernel,@function
parallel_sum__ssm_conv_h3__mixer_token_mlp__prompt_kernel:

    s_cmp_ge_u32 s2, 256
    s_cbranch_scc1 KF_DONE
    s_load_dwordx16 s[4:19], s[0:1], 0
    s_load_dwordx8 s[20:27], s[0:1], 64
    s_load_dwordx2 s[28:29], s[0:1], 104
    s_getpc_b64 s[44:45]
    s_and_b32 s44, s44, 0xffffff00
    s_and_b32 s45, s45, 0xffff
    s_mov_b32 s46, CODE_END-parallel_sum__ssm_conv_h3__mixer_token_mlp__prompt_kernel
    s_mov_b32 s47, 0x00020000
    s_lshr_b32 s48, s2, 3
    s_lshl_b32 s48, s48, 10
    v_lshrrev_b32 v1, 6, v0
    v_and_b32 v2, 7, v0
    v_lshlrev_b32 v2, 4, v2
    v_lshl_add_u32 v1, v1, 7, v2
    buffer_load_dwordx4 v[252:255], v1, s[44:47], s48 offen
    v_lshrrev_b32 v1, 6, v0
    v_and_b32 v2, 63, v0
    v_readfirstlane_b32 s40, v1
    s_nop 0
    s_cmp_lt_u32 s40, 4
    s_cbranch_scc1 KF_GEMM
    s_setprio 3
    s_sub_u32 s64, s40, 4
    s_and_b32 s66, s2, 7
    s_lshl_b32 s66, s66, 2
    s_lshr_b32 s67, s2, 3
    s_and_b32 s56, s67, 3
    s_add_u32 s66, s66, s56
    s_lshr_b32 s67, s67, 2
    s_mul_i32 s68, s66, 81920
    s_mul_i32 s56, s67, 160
    s_add_u32 s68, s68, s56
    s_mul_i32 s56, s64, 2560
    s_add_u32 s68, s68, s56
    s_movk_i32 s59, 10240-160
    v_mul_u32_u24 v40, 205, v2
    v_lshrrev_b32 v40, 11, v40
    v_lshlrev_b32 v3, 4, v2
    v_mad_u32_u24 v40, v40, s59, v3
    v_add_u32 v42, 64, v2
    v_mul_u32_u24 v41, 205, v42
    v_lshrrev_b32 v41, 11, v41
    v_lshlrev_b32 v42, 4, v42
    v_mad_u32_u24 v41, v41, s59, v42
    s_sub_u32 s58, s68, 3840
    v_add_u32 v42, s58, v40
    v_add_u32 v43, s58, v41
    v_add_u32 v44, 1280, v42
    v_add_u32 v45, 1280, v43
    s_mul_i32 s57, s64, 2880
    s_mul_i32 s60, s64, 2560
    s_mov_b32 s56, 0xffff
    s_cmp_lt_u32 s64, 2
    s_cselect_b32 s61, 0x3ffffff, s56
    s_cmp_lt_u32 s64, 1
    s_cselect_b32 s63, 0x3ffffff, s56
    s_waitcnt lgkmcnt(0)
    s_load_dwordx2 s[30:31], s[28:29], 0
    s_mov_b32 s44, s6
    s_and_b32 s45, s7, 0xffff
    s_mov_b32 s46, 2621440
    s_mov_b32 s47, 0x00020000
    s_mov_b32 s48, s8
    s_and_b32 s49, s9, 0xffff
    s_mov_b32 s50, 2621440
    s_mov_b32 s51, 0x00020000
    s_barrier
    s_add_u32 m0, s57, 110784
    s_nop 0
    buffer_load_dwordx4 v42, s[44:47], 0 offen  lds
    s_add_u32 m0, s57, 112224
    s_nop 0
    buffer_load_dwordx4 v44, s[44:47], 0 offen  lds
    s_add_u32 m0, s60, 123072
    s_nop 0
    buffer_load_dwordx4 v40, s[48:51], s68 offen  lds
    buffer_load_dwordx4 v40, s[48:51], s68 offen offset:1280  lds
    s_mov_b32 exec_hi, 0
    s_mov_b32 exec_lo, s61
    s_add_u32 m0, s57, 111808
    s_nop 0
    buffer_load_dwordx4 v43, s[44:47], 0 offen  lds
    s_mov_b32 exec_lo, s63
    s_add_u32 m0, s57, 113248
    s_nop 0
    buffer_load_dwordx4 v45, s[44:47], 0 offen  lds
    s_mov_b32 exec_lo, 0xffff
    s_add_u32 m0, s60, 124096
    s_nop 0
    buffer_load_dwordx4 v41, s[48:51], s68 offen  lds
    buffer_load_dwordx4 v41, s[48:51], s68 offen offset:1280  lds
    s_mov_b64 exec, -1
    s_branch KF_AUX
KF_GEMM:
    s_nop 4
    s_setprio 2
    s_and_b32 s64, s2, 7
    s_lshr_b32 s65, s2, 3
    s_lshr_b32 s41, s2, 2
    s_and_b32 s42, s2, 3
    s_lshl_b32 s43, s41, 5
    s_lshl_b32 s56, s42, 2
    s_add_u32 s43, s43, s56
    s_and_b32 s56, s40, 1
    s_lshl_b32 s56, s56, 1
    s_add_u32 s43, s43, s56
    s_lshr_b32 s56, s40, 1
    s_lshl_b32 s56, s56, 4
    s_add_u32 s43, s43, s56
    s_mul_i32 s43, s43, 1280
    v_lshlrev_b32 v3, 3, v2
    v_lshlrev_b32 v4, 2, v2
    v_add_u32 v5, 162048, v4
    v_mov_b32 v6, 0
    s_mov_b64 exec, 0xffff
    ds_write_b32 v5, v6
    s_mov_b64 exec, -1
    s_waitcnt lgkmcnt(0)
    s_load_dwordx2 s[30:31], s[28:29], 0
    s_mov_b32 s36, s4
    s_and_b32 s37, s5, 0xffff
    s_mov_b32 s38, 2621440
    s_mov_b32 s39, 0x00020000
    buffer_load_dwordx2 v[8:9], v3, s[36:39], s43 offen offset:0
    buffer_load_dwordx2 v[10:11], v3, s[36:39], s43 offen offset:512
    buffer_load_dword v12, v4, s[36:39], s43 offen offset:1024
    buffer_load_dwordx2 v[72:73], v3, s[36:39], s43 offen offset:1280
    buffer_load_dwordx2 v[74:75], v3, s[36:39], s43 offen offset:1792
    buffer_load_dword v76, v4, s[36:39], s43 offen offset:2304
    s_barrier
    s_mov_b32 s32, s28
    s_and_b32 s33, s29, 0xffff
    s_mov_b32 s34, 10027008
    s_mov_b32 s35, 0x00020000
    s_mul_i32 s66, s65, 171
    s_lshr_b32 s66, s66, 9
    s_mul_i32 s67, s66, 3
    s_sub_u32 s67, s65, s67
    s_mul_i32 s68, s66, 1639
    s_lshr_b32 s68, s68, 10
    s_and_b32 s68, s68, 15
    s_mul_i32 s69, s64, 3
    s_add_u32 s67, s67, s69
    v_lshlrev_b32 v68, 4, v2
    v_bfe_u32 v69, v2, 1, 2
    v_lshrrev_b32 v70, 4, v2
    v_xor_b32 v69, v69, v70
    v_lshlrev_b32 v69, 5, v69
    v_and_b32 v70, 1, v2
    v_lshl_add_u32 v69, v70, 4, v69
    v_lshrrev_b32 v70, 3, v2
    s_movk_i32 s56, 3072
    v_mad_u32_u24 v56, v70, s56, v69
    v_add_u32 v57, 23552, v56
    v_add_u32 v58, 47104, v56
    v_add_u32 v59, 70656, v56
    s_mul_i32 s44, s40, 1572864
    s_lshl_b32 s56, s67, 7
    s_add_u32 s44, s44, s56
    s_mul_i32 s45, s40, 24576
    s_mov_b32 s46, s68
    s_mov_b32 s48, s18
    s_and_b32 s49, s19, 0xffff
    s_mov_b32 s50, 6291456
    s_mov_b32 s51, 0x00020000
    v_lshrrev_b32 v71, 2, v2
    v_lshlrev_b32 v71, 7, v71
    v_and_b32 v70, 3, v2
    v_lshl_add_u32 v71, v70, 3, v71
    v_add_u32 v71, s45, v71
    v_bfe_u32 v70, v2, 3, 2
    v_xor_b32 v13, 0, v70
    v_lshl_add_u32 v60, v13, 5, v71
    v_xor_b32 v13, 1, v70
    v_lshl_add_u32 v61, v13, 5, v71
    v_xor_b32 v13, 2, v70
    v_lshl_add_u32 v62, v13, 5, v71
    v_xor_b32 v13, 3, v70
    v_lshl_add_u32 v63, v13, 5, v71
    s_add_u32 s56, s40, 0
    s_and_b32 s56, s56, 3
    s_lshl_b32 s56, s56, 10
    v_add_u32 v64, s56, v68
    s_add_u32 s56, s40, 1
    s_and_b32 s56, s56, 3
    s_lshl_b32 s56, s56, 10
    v_add_u32 v65, s56, v68
    s_add_u32 s56, s40, 2
    s_and_b32 s56, s56, 3
    s_lshl_b32 s56, s56, 10
    v_add_u32 v66, s56, v68
    s_add_u32 s56, s40, 3
    s_and_b32 s56, s56, 3
    s_lshl_b32 s56, s56, 10
    v_add_u32 v67, s56, v68
    s_mul_i32 s56, s40, 2688
    s_add_u32 s56, s56, 148224
    v_add_u32 v5, s56, v3
    v_add_u32 v6, s56, v4
    v_bfe_u32 v40, v2, 2, 2
    s_movk_i32 s57, 1344
    v_mul_u32_u24 v40, s57, v40
    v_lshrrev_b32 v41, 4, v2
    v_lshl_add_u32 v40, v41, 5, v40
    v_and_b32 v42, 3, v2
    v_lshl_add_u32 v40, v42, 3, v40
    s_lshl_b32 s57, s40, 7
    s_add_u32 s57, s57, 148224
    v_add_u32 v40, s57, v40
    v_and_b32 v42, 15, v2
    v_lshlrev_b32 v42, 4, v42
    v_lshl_add_u32 v42, v41, 10, v42
    s_lshl_b32 s57, s40, 6
    s_add_u32 s57, s57, s41
    s_lshl_b32 s57, s57, 12
    s_lshl_b32 s58, s42, 8
    s_add_u32 s57, s57, s58
    s_add_u32 s57, s57, 196608
    s_lshl_b32 s59, s40, 8
    s_add_u32 s59, s59, s2
    s_mul_i32 s59, s59, 16
    s_add_u32 s59, s59, 92160
    s_mov_b32 s60, 0x3acccccd
    s_lshl_b32 s61, s40, 4
    s_add_u32 s61, s61, 162112
    v_mov_b32 v43, s61
    v_lshlrev_b32 v54, 14, v2
    s_waitcnt lgkmcnt(0)
    s_add_u32 s30, s30, 0x9E3779B9
    s_add_u32 s31, s31, 0x7F4A7C15
    s_waitcnt vmcnt(0)
    v_lshlrev_b32 v16, 16, v8
    v_lshlrev_b32 v80, 16, v72
    v_and_b32 v17, 0xffff0000, v8
    v_and_b32 v81, 0xffff0000, v72
    v_lshlrev_b32 v18, 16, v9
    v_lshlrev_b32 v82, 16, v73
    v_and_b32 v19, 0xffff0000, v9
    v_and_b32 v83, 0xffff0000, v73
    v_lshlrev_b32 v20, 16, v10
    v_lshlrev_b32 v84, 16, v74
    v_and_b32 v21, 0xffff0000, v10
    v_and_b32 v85, 0xffff0000, v74
    v_lshlrev_b32 v22, 16, v11
    v_lshlrev_b32 v86, 16, v75
    v_and_b32 v23, 0xffff0000, v11
    v_and_b32 v87, 0xffff0000, v75
    v_lshlrev_b32 v24, 16, v12
    v_lshlrev_b32 v88, 16, v76
    v_and_b32 v25, 0xffff0000, v12
    v_and_b32 v89, 0xffff0000, v76
    v_readfirstlane_b32 s62, v16
    v_readfirstlane_b32 s63, v80
    s_nop 0
    v_subrev_f32 v44, s62, v16
    v_subrev_f32 v92, s63, v80
    v_subrev_f32 v45, s62, v17
    v_subrev_f32 v93, s63, v81
    v_subrev_f32 v46, s62, v18
    v_subrev_f32 v94, s63, v82
    v_subrev_f32 v47, s62, v19
    v_subrev_f32 v95, s63, v83
    v_subrev_f32 v48, s62, v20
    v_subrev_f32 v96, s63, v84
    v_subrev_f32 v49, s62, v21
    v_subrev_f32 v97, s63, v85
    v_subrev_f32 v50, s62, v22
    v_subrev_f32 v98, s63, v86
    v_subrev_f32 v51, s62, v23
    v_subrev_f32 v99, s63, v87
    v_subrev_f32 v52, s62, v24
    v_subrev_f32 v100, s63, v88
    v_subrev_f32 v53, s62, v25
    v_subrev_f32 v101, s63, v89
    v_pk_add_f32 v[26:27], v[44:45], v[46:47]
    v_pk_add_f32 v[104:105], v[92:93], v[94:95]
    v_pk_mul_f32 v[28:29], v[44:45], v[44:45]
    v_pk_mul_f32 v[106:107], v[92:93], v[92:93]
    v_pk_fma_f32 v[28:29], v[46:47], v[46:47], v[28:29]
    v_pk_fma_f32 v[106:107], v[94:95], v[94:95], v[106:107]
    v_pk_add_f32 v[26:27], v[26:27], v[48:49]
    v_pk_add_f32 v[104:105], v[104:105], v[96:97]
    v_pk_fma_f32 v[28:29], v[48:49], v[48:49], v[28:29]
    v_pk_fma_f32 v[106:107], v[96:97], v[96:97], v[106:107]
    v_pk_add_f32 v[26:27], v[26:27], v[50:51]
    v_pk_add_f32 v[104:105], v[104:105], v[98:99]
    v_pk_fma_f32 v[28:29], v[50:51], v[50:51], v[28:29]
    v_pk_fma_f32 v[106:107], v[98:99], v[98:99], v[106:107]
    v_pk_add_f32 v[26:27], v[26:27], v[52:53]
    v_pk_add_f32 v[104:105], v[104:105], v[100:101]
    v_pk_fma_f32 v[28:29], v[52:53], v[52:53], v[28:29]
    v_pk_fma_f32 v[106:107], v[100:101], v[100:101], v[106:107]
    v_add_f32 v26, v26, v27
    v_add_f32 v104, v104, v105
    v_add_f32 v28, v28, v29
    v_add_f32 v106, v106, v107
    v_add_f32_dpp v26, v26, v26 quad_perm:[1,0,3,2] row_mask:0xf bank_mask:0xf
    v_add_f32_dpp v104, v104, v104 quad_perm:[1,0,3,2] row_mask:0xf bank_mask:0xf
    v_add_f32_dpp v28, v28, v28 quad_perm:[1,0,3,2] row_mask:0xf bank_mask:0xf
    v_add_f32_dpp v106, v106, v106 quad_perm:[1,0,3,2] row_mask:0xf bank_mask:0xf
    v_add_f32_dpp v26, v26, v26 quad_perm:[2,3,0,1] row_mask:0xf bank_mask:0xf
    v_add_f32_dpp v104, v104, v104 quad_perm:[2,3,0,1] row_mask:0xf bank_mask:0xf
    v_add_f32_dpp v28, v28, v28 quad_perm:[2,3,0,1] row_mask:0xf bank_mask:0xf
    v_add_f32_dpp v106, v106, v106 quad_perm:[2,3,0,1] row_mask:0xf bank_mask:0xf
    v_add_f32_dpp v26, v26, v26 row_half_mirror row_mask:0xf bank_mask:0xf
    v_add_f32_dpp v104, v104, v104 row_half_mirror row_mask:0xf bank_mask:0xf
    v_add_f32_dpp v28, v28, v28 row_half_mirror row_mask:0xf bank_mask:0xf
    v_add_f32_dpp v106, v106, v106 row_half_mirror row_mask:0xf bank_mask:0xf
    v_add_f32_dpp v26, v26, v26 row_mirror row_mask:0xf bank_mask:0xf
    v_add_f32_dpp v104, v104, v104 row_mirror row_mask:0xf bank_mask:0xf
    v_add_f32_dpp v28, v28, v28 row_mirror row_mask:0xf bank_mask:0xf
    v_add_f32_dpp v106, v106, v106 row_mirror row_mask:0xf bank_mask:0xf
    v_mov_b32 v27, v26
    v_mov_b32 v105, v104
    v_mov_b32 v29, v28
    v_mov_b32 v107, v106
    v_permlane16_swap_b32 v26, v27
    v_permlane16_swap_b32 v104, v105
    v_permlane16_swap_b32 v28, v29
    v_permlane16_swap_b32 v106, v107
    v_add_f32 v26, v26, v27
    v_add_f32 v104, v104, v105
    v_add_f32 v28, v28, v29
    v_add_f32 v106, v106, v107
    v_mov_b32 v27, v26
    v_mov_b32 v105, v104
    v_mov_b32 v29, v28
    v_mov_b32 v107, v106
    v_permlane32_swap_b32 v26, v27
    v_permlane32_swap_b32 v104, v105
    v_permlane32_swap_b32 v28, v29
    v_permlane32_swap_b32 v106, v107
    v_add_f32 v26, v26, v27
    v_add_f32 v104, v104, v105
    v_add_f32 v28, v28, v29
    v_add_f32 v106, v106, v107
    v_mul_f32 v26, s60, v26
    v_mul_f32 v104, s60, v104
    v_mul_f32 v28, s60, v28
    v_mul_f32 v106, s60, v106
    v_fma_f32 v28, -v26, v26, v28
    v_fma_f32 v106, -v104, v104, v106
    v_max_f32 v28, 0, v28
    v_max_f32 v106, 0, v106
    v_add_f32 v26, s62, v26
    v_add_f32 v104, s63, v104
    v_cvt_pk_bf16_f32 v27, v26, v28
    v_cvt_pk_bf16_f32 v105, v104, v106
    v_lshlrev_b32 v30, 16, v27
    v_lshlrev_b32 v108, 16, v105
    v_and_b32 v28, 0xffff0000, v27
    v_and_b32 v106, 0xffff0000, v105
    v_add_f32 v28, 0x3727c5ac, v28
    v_add_f32 v106, 0x3727c5ac, v106
    v_cvt_pk_bf16_f32 v28, v28, v28
    v_cvt_pk_bf16_f32 v106, v106, v106
    v_lshlrev_b32 v28, 16, v28
    v_lshlrev_b32 v106, 16, v106
    v_sqrt_f32 v28, v28
    v_sqrt_f32 v106, v106
    v_cvt_pk_bf16_f32 v28, v28, v28
    v_cvt_pk_bf16_f32 v106, v106, v106
    v_lshlrev_b32 v28, 16, v28
    v_lshlrev_b32 v106, 16, v106
    v_rcp_f32 v31, v28
    v_rcp_f32 v109, v106
    s_mov_b64 exec, 1
    ds_write_b64 v43, v[30:31]
    ds_write_b64 v43, v[108:109] offset:8
    s_mov_b64 exec, -1
    v_pk_add_f32 v[44:45], v[16:17], v[30:31] op_sel_hi:[1,0] neg_lo:[0,1] neg_hi:[0,1]
    v_pk_add_f32 v[92:93], v[80:81], v[108:109] op_sel_hi:[1,0] neg_lo:[0,1] neg_hi:[0,1]
    v_pk_add_f32 v[46:47], v[18:19], v[30:31] op_sel_hi:[1,0] neg_lo:[0,1] neg_hi:[0,1]
    v_pk_add_f32 v[94:95], v[82:83], v[108:109] op_sel_hi:[1,0] neg_lo:[0,1] neg_hi:[0,1]
    v_pk_add_f32 v[48:49], v[20:21], v[30:31] op_sel_hi:[1,0] neg_lo:[0,1] neg_hi:[0,1]
    v_pk_add_f32 v[96:97], v[84:85], v[108:109] op_sel_hi:[1,0] neg_lo:[0,1] neg_hi:[0,1]
    v_pk_add_f32 v[50:51], v[22:23], v[30:31] op_sel_hi:[1,0] neg_lo:[0,1] neg_hi:[0,1]
    v_pk_add_f32 v[98:99], v[86:87], v[108:109] op_sel_hi:[1,0] neg_lo:[0,1] neg_hi:[0,1]
    v_pk_add_f32 v[52:53], v[24:25], v[30:31] op_sel_hi:[1,0] neg_lo:[0,1] neg_hi:[0,1]
    v_pk_add_f32 v[100:101], v[88:89], v[108:109] op_sel_hi:[1,0] neg_lo:[0,1] neg_hi:[0,1]
    v_cvt_pk_bf16_f32 v8, v44, v45
    v_cvt_pk_bf16_f32 v72, v92, v93
    v_cvt_pk_bf16_f32 v9, v46, v47
    v_cvt_pk_bf16_f32 v73, v94, v95
    v_cvt_pk_bf16_f32 v10, v48, v49
    v_cvt_pk_bf16_f32 v74, v96, v97
    v_cvt_pk_bf16_f32 v11, v50, v51
    v_cvt_pk_bf16_f32 v75, v98, v99
    v_cvt_pk_bf16_f32 v12, v52, v53
    v_cvt_pk_bf16_f32 v76, v100, v101
    v_lshlrev_b32 v44, 16, v8
    v_lshlrev_b32 v92, 16, v72
    v_and_b32 v45, 0xffff0000, v8
    v_and_b32 v93, 0xffff0000, v72
    v_lshlrev_b32 v46, 16, v9
    v_lshlrev_b32 v94, 16, v73
    v_and_b32 v47, 0xffff0000, v9
    v_and_b32 v95, 0xffff0000, v73
    v_lshlrev_b32 v48, 16, v10
    v_lshlrev_b32 v96, 16, v74
    v_and_b32 v49, 0xffff0000, v10
    v_and_b32 v97, 0xffff0000, v74
    v_lshlrev_b32 v50, 16, v11
    v_lshlrev_b32 v98, 16, v75
    v_and_b32 v51, 0xffff0000, v11
    v_and_b32 v99, 0xffff0000, v75
    v_lshlrev_b32 v52, 16, v12
    v_lshlrev_b32 v100, 16, v76
    v_and_b32 v53, 0xffff0000, v12
    v_and_b32 v101, 0xffff0000, v76
    v_pk_mul_f32 v[44:45], v[44:45], v[30:31] op_sel:[0,1] op_sel_hi:[1,1]
    v_pk_mul_f32 v[92:93], v[92:93], v[108:109] op_sel:[0,1] op_sel_hi:[1,1]
    v_pk_mul_f32 v[46:47], v[46:47], v[30:31] op_sel:[0,1] op_sel_hi:[1,1]
    v_pk_mul_f32 v[94:95], v[94:95], v[108:109] op_sel:[0,1] op_sel_hi:[1,1]
    v_pk_mul_f32 v[48:49], v[48:49], v[30:31] op_sel:[0,1] op_sel_hi:[1,1]
    v_pk_mul_f32 v[96:97], v[96:97], v[108:109] op_sel:[0,1] op_sel_hi:[1,1]
    v_pk_mul_f32 v[50:51], v[50:51], v[30:31] op_sel:[0,1] op_sel_hi:[1,1]
    v_pk_mul_f32 v[98:99], v[98:99], v[108:109] op_sel:[0,1] op_sel_hi:[1,1]
    v_pk_mul_f32 v[52:53], v[52:53], v[30:31] op_sel:[0,1] op_sel_hi:[1,1]
    v_pk_mul_f32 v[100:101], v[100:101], v[108:109] op_sel:[0,1] op_sel_hi:[1,1]
    v_cvt_pk_bf16_f32 v8, v44, v45
    v_cvt_pk_bf16_f32 v72, v92, v93
    v_cvt_pk_bf16_f32 v9, v46, v47
    v_cvt_pk_bf16_f32 v73, v94, v95
    v_cvt_pk_bf16_f32 v10, v48, v49
    v_cvt_pk_bf16_f32 v74, v96, v97
    v_cvt_pk_bf16_f32 v11, v50, v51
    v_cvt_pk_bf16_f32 v75, v98, v99
    v_cvt_pk_bf16_f32 v12, v52, v53
    v_cvt_pk_bf16_f32 v76, v100, v101
    v_lshlrev_b32 v16, 16, v8
    v_lshlrev_b32 v80, 16, v72
    v_and_b32 v17, 0xffff0000, v8
    v_and_b32 v81, 0xffff0000, v72
    v_lshlrev_b32 v18, 16, v9
    v_lshlrev_b32 v82, 16, v73
    v_and_b32 v19, 0xffff0000, v9
    v_and_b32 v83, 0xffff0000, v73
    v_lshlrev_b32 v20, 16, v10
    v_lshlrev_b32 v84, 16, v74
    v_and_b32 v21, 0xffff0000, v10
    v_and_b32 v85, 0xffff0000, v74
    v_lshlrev_b32 v22, 16, v11
    v_lshlrev_b32 v86, 16, v75
    v_and_b32 v23, 0xffff0000, v11
    v_and_b32 v87, 0xffff0000, v75
    v_lshlrev_b32 v24, 16, v12
    v_lshlrev_b32 v88, 16, v76
    v_and_b32 v25, 0xffff0000, v12
    v_and_b32 v89, 0xffff0000, v76
    v_pk_add_f32 v[26:27], v[16:17], v[18:19]
    v_pk_add_f32 v[104:105], v[80:81], v[82:83]
    v_pk_mul_f32 v[28:29], v[16:17], v[16:17]
    v_pk_mul_f32 v[106:107], v[80:81], v[80:81]
    v_pk_fma_f32 v[28:29], v[18:19], v[18:19], v[28:29]
    v_pk_fma_f32 v[106:107], v[82:83], v[82:83], v[106:107]
    v_pk_add_f32 v[26:27], v[26:27], v[20:21]
    v_pk_add_f32 v[104:105], v[104:105], v[84:85]
    v_pk_fma_f32 v[28:29], v[20:21], v[20:21], v[28:29]
    v_pk_fma_f32 v[106:107], v[84:85], v[84:85], v[106:107]
    v_pk_add_f32 v[26:27], v[26:27], v[22:23]
    v_pk_add_f32 v[104:105], v[104:105], v[86:87]
    v_pk_fma_f32 v[28:29], v[22:23], v[22:23], v[28:29]
    v_pk_fma_f32 v[106:107], v[86:87], v[86:87], v[106:107]
    v_pk_add_f32 v[26:27], v[26:27], v[24:25]
    v_pk_add_f32 v[104:105], v[104:105], v[88:89]
    v_pk_fma_f32 v[28:29], v[24:25], v[24:25], v[28:29]
    v_pk_fma_f32 v[106:107], v[88:89], v[88:89], v[106:107]
    v_add_f32 v26, v26, v27
    v_add_f32 v104, v104, v105
    v_add_f32 v28, v28, v29
    v_add_f32 v106, v106, v107
    v_add_f32_dpp v26, v26, v26 quad_perm:[1,0,3,2] row_mask:0xf bank_mask:0xf
    v_add_f32_dpp v104, v104, v104 quad_perm:[1,0,3,2] row_mask:0xf bank_mask:0xf
    v_add_f32_dpp v28, v28, v28 quad_perm:[1,0,3,2] row_mask:0xf bank_mask:0xf
    v_add_f32_dpp v106, v106, v106 quad_perm:[1,0,3,2] row_mask:0xf bank_mask:0xf
    v_add_f32_dpp v26, v26, v26 quad_perm:[2,3,0,1] row_mask:0xf bank_mask:0xf
    v_add_f32_dpp v104, v104, v104 quad_perm:[2,3,0,1] row_mask:0xf bank_mask:0xf
    v_add_f32_dpp v28, v28, v28 quad_perm:[2,3,0,1] row_mask:0xf bank_mask:0xf
    v_add_f32_dpp v106, v106, v106 quad_perm:[2,3,0,1] row_mask:0xf bank_mask:0xf
    v_add_f32_dpp v26, v26, v26 row_half_mirror row_mask:0xf bank_mask:0xf
    v_add_f32_dpp v104, v104, v104 row_half_mirror row_mask:0xf bank_mask:0xf
    v_add_f32_dpp v28, v28, v28 row_half_mirror row_mask:0xf bank_mask:0xf
    v_add_f32_dpp v106, v106, v106 row_half_mirror row_mask:0xf bank_mask:0xf
    v_add_f32_dpp v26, v26, v26 row_mirror row_mask:0xf bank_mask:0xf
    v_add_f32_dpp v104, v104, v104 row_mirror row_mask:0xf bank_mask:0xf
    v_add_f32_dpp v28, v28, v28 row_mirror row_mask:0xf bank_mask:0xf
    v_add_f32_dpp v106, v106, v106 row_mirror row_mask:0xf bank_mask:0xf
    v_mov_b32 v27, v26
    v_mov_b32 v105, v104
    v_mov_b32 v29, v28
    v_mov_b32 v107, v106
    v_permlane16_swap_b32 v26, v27
    v_permlane16_swap_b32 v104, v105
    v_permlane16_swap_b32 v28, v29
    v_permlane16_swap_b32 v106, v107
    v_add_f32 v26, v26, v27
    v_add_f32 v104, v104, v105
    v_add_f32 v28, v28, v29
    v_add_f32 v106, v106, v107
    v_mov_b32 v27, v26
    v_mov_b32 v105, v104
    v_mov_b32 v29, v28
    v_mov_b32 v107, v106
    v_permlane32_swap_b32 v26, v27
    v_permlane32_swap_b32 v104, v105
    v_permlane32_swap_b32 v28, v29
    v_permlane32_swap_b32 v106, v107
    v_add_f32 v26, v26, v27
    v_add_f32 v104, v104, v105
    v_add_f32 v28, v28, v29
    v_add_f32 v106, v106, v107
    v_mul_f32 v26, s60, v26
    v_mul_f32 v104, s60, v104
    v_mul_f32 v28, s60, v28
    v_mul_f32 v106, s60, v106
    v_fma_f32 v28, -v26, v26, v28
    v_fma_f32 v106, -v104, v104, v106
    v_max_f32 v28, 0, v28
    v_max_f32 v106, 0, v106
    v_cvt_pk_bf16_f32 v27, v26, v28
    v_cvt_pk_bf16_f32 v105, v104, v106
    v_lshlrev_b32 v30, 16, v27
    v_lshlrev_b32 v108, 16, v105
    v_and_b32 v28, 0xffff0000, v27
    v_and_b32 v106, 0xffff0000, v105
    v_add_f32 v28, 0x3727c5ac, v28
    v_add_f32 v106, 0x3727c5ac, v106
    v_cvt_pk_bf16_f32 v28, v28, v28
    v_cvt_pk_bf16_f32 v106, v106, v106
    v_lshlrev_b32 v28, 16, v28
    v_lshlrev_b32 v106, 16, v106
    v_sqrt_f32 v28, v28
    v_sqrt_f32 v106, v106
    v_cvt_pk_bf16_f32 v28, v28, v28
    v_cvt_pk_bf16_f32 v106, v106, v106
    v_lshlrev_b32 v28, 16, v28
    v_lshlrev_b32 v106, 16, v106
    v_rcp_f32 v31, v28
    v_rcp_f32 v109, v106
    v_pk_add_f32 v[44:45], v[16:17], v[30:31] op_sel_hi:[1,0] neg_lo:[0,1] neg_hi:[0,1]
    v_pk_add_f32 v[92:93], v[80:81], v[108:109] op_sel_hi:[1,0] neg_lo:[0,1] neg_hi:[0,1]
    v_pk_add_f32 v[46:47], v[18:19], v[30:31] op_sel_hi:[1,0] neg_lo:[0,1] neg_hi:[0,1]
    v_pk_add_f32 v[94:95], v[82:83], v[108:109] op_sel_hi:[1,0] neg_lo:[0,1] neg_hi:[0,1]
    v_pk_add_f32 v[48:49], v[20:21], v[30:31] op_sel_hi:[1,0] neg_lo:[0,1] neg_hi:[0,1]
    v_pk_add_f32 v[96:97], v[84:85], v[108:109] op_sel_hi:[1,0] neg_lo:[0,1] neg_hi:[0,1]
    v_pk_add_f32 v[50:51], v[22:23], v[30:31] op_sel_hi:[1,0] neg_lo:[0,1] neg_hi:[0,1]
    v_pk_add_f32 v[98:99], v[86:87], v[108:109] op_sel_hi:[1,0] neg_lo:[0,1] neg_hi:[0,1]
    v_pk_add_f32 v[52:53], v[24:25], v[30:31] op_sel_hi:[1,0] neg_lo:[0,1] neg_hi:[0,1]
    v_pk_add_f32 v[100:101], v[88:89], v[108:109] op_sel_hi:[1,0] neg_lo:[0,1] neg_hi:[0,1]
    v_cvt_pk_bf16_f32 v8, v44, v45
    v_cvt_pk_bf16_f32 v72, v92, v93
    v_cvt_pk_bf16_f32 v9, v46, v47
    v_cvt_pk_bf16_f32 v73, v94, v95
    v_cvt_pk_bf16_f32 v10, v48, v49
    v_cvt_pk_bf16_f32 v74, v96, v97
    v_cvt_pk_bf16_f32 v11, v50, v51
    v_cvt_pk_bf16_f32 v75, v98, v99
    v_cvt_pk_bf16_f32 v12, v52, v53
    v_cvt_pk_bf16_f32 v76, v100, v101
    v_lshlrev_b32 v44, 16, v8
    v_lshlrev_b32 v92, 16, v72
    v_and_b32 v45, 0xffff0000, v8
    v_and_b32 v93, 0xffff0000, v72
    v_lshlrev_b32 v46, 16, v9
    v_lshlrev_b32 v94, 16, v73
    v_and_b32 v47, 0xffff0000, v9
    v_and_b32 v95, 0xffff0000, v73
    v_lshlrev_b32 v48, 16, v10
    v_lshlrev_b32 v96, 16, v74
    v_and_b32 v49, 0xffff0000, v10
    v_and_b32 v97, 0xffff0000, v74
    v_lshlrev_b32 v50, 16, v11
    v_lshlrev_b32 v98, 16, v75
    v_and_b32 v51, 0xffff0000, v11
    v_and_b32 v99, 0xffff0000, v75
    v_lshlrev_b32 v52, 16, v12
    v_lshlrev_b32 v100, 16, v76
    v_and_b32 v53, 0xffff0000, v12
    v_and_b32 v101, 0xffff0000, v76
    v_pk_mul_f32 v[44:45], v[44:45], v[30:31] op_sel:[0,1] op_sel_hi:[1,1]
    v_pk_mul_f32 v[92:93], v[92:93], v[108:109] op_sel:[0,1] op_sel_hi:[1,1]
    v_pk_mul_f32 v[46:47], v[46:47], v[30:31] op_sel:[0,1] op_sel_hi:[1,1]
    v_pk_mul_f32 v[94:95], v[94:95], v[108:109] op_sel:[0,1] op_sel_hi:[1,1]
    v_pk_mul_f32 v[48:49], v[48:49], v[30:31] op_sel:[0,1] op_sel_hi:[1,1]
    v_pk_mul_f32 v[96:97], v[96:97], v[108:109] op_sel:[0,1] op_sel_hi:[1,1]
    v_pk_mul_f32 v[50:51], v[50:51], v[30:31] op_sel:[0,1] op_sel_hi:[1,1]
    v_pk_mul_f32 v[98:99], v[98:99], v[108:109] op_sel:[0,1] op_sel_hi:[1,1]
    v_pk_mul_f32 v[52:53], v[52:53], v[30:31] op_sel:[0,1] op_sel_hi:[1,1]
    v_pk_mul_f32 v[100:101], v[100:101], v[108:109] op_sel:[0,1] op_sel_hi:[1,1]
    v_cvt_pk_bf16_f32 v8, v44, v45
    v_cvt_pk_bf16_f32 v72, v92, v93
    v_cvt_pk_bf16_f32 v9, v46, v47
    v_cvt_pk_bf16_f32 v73, v94, v95
    v_cvt_pk_bf16_f32 v10, v48, v49
    v_cvt_pk_bf16_f32 v74, v96, v97
    v_cvt_pk_bf16_f32 v11, v50, v51
    v_cvt_pk_bf16_f32 v75, v98, v99
    v_cvt_pk_bf16_f32 v12, v52, v53
    v_cvt_pk_bf16_f32 v76, v100, v101
    ds_write_b64 v5, v[8:9] offset:0
    ds_write_b64 v5, v[10:11] offset:512
    ds_write_b32 v6, v12 offset:1024
    ds_write_b64 v5, v[72:73] offset:1344
    ds_write_b64 v5, v[74:75] offset:1856
    ds_write_b32 v6, v76 offset:2368
    v_mov_b32 v44, 162064
    v_mov_b32 v45, 1
    s_waitcnt lgkmcnt(0)
    s_mov_b64 exec, 1
    ds_add_u32 v44, v45
    s_mov_b64 exec, -1
    v_mov_b32 v44, 162064
    s_mov_b32 s70, 0
LW_1:
    s_nop 4
    ds_read_b32 v45, v44
    s_add_u32 s70, s70, 1
    s_waitcnt lgkmcnt(0)
    v_readfirstlane_b32 s71, v45
    s_cmp_gt_u32 s70, 262144
    s_cbranch_scc1 LWX_2
    s_cmp_ge_u32 s71, 8
    s_cbranch_scc1 LWX_2
    s_branch LW_1
LWX_2:
    s_nop 4
    ds_read_b64_tr_b16 v[16:17], v40 offset:0
    ds_read_b64_tr_b16 v[18:19], v40 offset:5376
    ds_read_b64_tr_b16 v[20:21], v40 offset:512
    ds_read_b64_tr_b16 v[22:23], v40 offset:5888
    s_add_u32 s58, s57, 1048576
    s_waitcnt lgkmcnt(2)
    buffer_store_dwordx4 v[16:19], v42, s[32:35], s57 offen sc1
    s_mov_b32 s56, 3
    s_cmp_ge_u32 s40, 2
    s_cbranch_scc1 LN1_3
    ds_read_b64_tr_b16 v[24:25], v40 offset:1024
    ds_read_b64_tr_b16 v[26:27], v40 offset:6400
    v_add_u32 v44, 162112, v3
    ds_read_b64 v[28:29], v44
    s_add_u32 s57, s57, 2097152
    s_lshl_b32 s61, s2, 6
    s_add_u32 s61, s61, 133120
    s_mov_b32 s56, 7
    s_waitcnt lgkmcnt(0)
    buffer_store_dwordx4 v[24:27], v42, s[32:35], s57 offen sc1
    s_mov_b64 exec, 0xff
    buffer_store_dwordx2 v[28:29], v3, s[32:35], s61 offen sc1
    s_mov_b64 exec, -1
LN1_3:
    s_nop 4
    s_waitcnt lgkmcnt(0)
    buffer_store_dwordx4 v[20:23], v42, s[32:35], s58 offen sc1
    v_mov_b32 v44, 162068
    v_mov_b32 v45, 1
    s_waitcnt lgkmcnt(0)
    s_mov_b64 exec, 1
    ds_add_u32 v44, v45
    s_mov_b64 exec, -1
    v_mov_b32 v44, s30
    v_mov_b32 v45, s31
    s_mov_b32 s61, s56
    s_waitcnt vmcnt(0)
    s_mov_b32 exec_lo, s61
    s_mov_b32 exec_hi, 0
    buffer_store_dwordx2 v[44:45], v54, s[32:35], s59 offen sc1
    s_mov_b64 exec, -1
    s_cmp_ge_u32 s2, 240
    s_cbranch_scc1 KF_G2
    s_mul_i32 s47, s46, 98304
    s_add_u32 s47, s47, s44
    s_add_u32 m0, s45, 0
    s_add_u32 s46, s46, 1
    s_and_b32 s46, s46, 15
    buffer_load_dwordx4 v56, s[48:51], s47 offen offset:0  lds
    buffer_load_dwordx4 v57, s[48:51], s47 offen offset:1024  lds
    buffer_load_dwordx4 v58, s[48:51], s47 offen offset:2048  lds
    buffer_load_dwordx4 v59, s[48:51], s47 offen offset:3072  lds
    v_mov_b32 v4, 162076
    s_mov_b32 s70, 0
LW_4:
    s_nop 4
    ds_read_b32 v5, v4
    s_add_u32 s70, s70, 1
    s_waitcnt lgkmcnt(0)
    v_readfirstlane_b32 s71, v5
    s_cmp_gt_u32 s70, 262144
    s_cbranch_scc1 LWX_5
    s_cmp_ge_u32 s71, 4
    s_cbranch_scc1 LWX_5
    s_sleep 1
    s_branch LW_4
LWX_5:
    s_nop 4
    s_mul_i32 s47, s46, 98304
    s_add_u32 s47, s47, s44
    s_add_u32 m0, s45, 4096
    s_add_u32 s46, s46, 1
    s_and_b32 s46, s46, 15
    buffer_load_dwordx4 v56, s[48:51], s47 offen offset:0  lds
    buffer_load_dwordx4 v57, s[48:51], s47 offen offset:1024  lds
    buffer_load_dwordx4 v58, s[48:51], s47 offen offset:2048  lds
    buffer_load_dwordx4 v59, s[48:51], s47 offen offset:3072  lds
    s_lshl_b32 s57, s66, 6
    s_lshl_b32 s56, s40, 4
    s_add_u32 s57, s57, s56
    s_lshl_b32 s57, s57, 12
    s_add_u32 s57, s57, 196608
    s_lshl_b32 s58, s68, 12
    s_lshl_b32 s59, s66, 8
    s_lshl_b32 s56, s40, 6
    s_add_u32 s59, s59, s56
    s_mul_i32 s59, s59, 16
    s_add_u32 s59, s59, 92160
    s_mov_b32 s52, s20
    s_and_b32 s53, s21, 0xffff
    s_mov_b32 s54, 3072
    s_mov_b32 s55, 0x00020000
    v_lshrrev_b32 v3, 4, v2
    v_lshlrev_b32 v3, 3, v3
    s_lshl_b32 s56, s67, 7
    buffer_load_dwordx2 v[248:249], v3, s[52:55], s56 offen offset:0
    buffer_load_dwordx2 v[250:251], v3, s[52:55], s56 offen offset:32
    buffer_load_dwordx2 v[252:253], v3, s[52:55], s56 offen offset:64
    buffer_load_dwordx2 v[254:255], v3, s[52:55], s56 offen offset:96
    s_waitcnt vmcnt(4)
    v_mov_b32 v4, 162080
    v_mov_b32 v5, 1
    s_waitcnt lgkmcnt(0)
    s_mov_b64 exec, 1
    ds_add_u32 v4, v5
    s_mov_b64 exec, -1
    s_mul_i32 s47, s46, 98304
    s_add_u32 s47, s47, s44
    s_add_u32 m0, s45, 8192
    s_add_u32 s46, s46, 1
    s_and_b32 s46, s46, 15
    buffer_load_dwordx4 v56, s[48:51], s47 offen offset:0  lds
    buffer_load_dwordx4 v57, s[48:51], s47 offen offset:1024  lds
    buffer_load_dwordx4 v58, s[48:51], s47 offen offset:2048  lds
    buffer_load_dwordx4 v59, s[48:51], s47 offen offset:3072  lds
    s_mul_i32 s47, s46, 98304
    s_add_u32 s47, s47, s44
    s_add_u32 m0, s45, 12288
    s_add_u32 s46, s46, 1
    s_and_b32 s46, s46, 15
    buffer_load_dwordx4 v56, s[48:51], s47 offen offset:0  lds
    buffer_load_dwordx4 v57, s[48:51], s47 offen offset:1024  lds
    buffer_load_dwordx4 v58, s[48:51], s47 offen offset:2048  lds
    buffer_load_dwordx4 v59, s[48:51], s47 offen offset:3072  lds
    s_mul_i32 s47, s46, 98304
    s_add_u32 s47, s47, s44
    s_add_u32 m0, s45, 16384
    s_add_u32 s46, s46, 1
    s_and_b32 s46, s46, 15
    buffer_load_dwordx4 v56, s[48:51], s47 offen offset:0  lds
    buffer_load_dwordx4 v57, s[48:51], s47 offen offset:1024  lds
    buffer_load_dwordx4 v58, s[48:51], s47 offen offset:2048  lds
    buffer_load_dwordx4 v59, s[48:51], s47 offen offset:3072  lds
    ds_read_b64_tr_b16 v[152:153], v60 offset:0
    ds_read_b64_tr_b16 v[154:155], v60 offset:2048
    ds_read_b64_tr_b16 v[156:157], v61 offset:0
    ds_read_b64_tr_b16 v[158:159], v61 offset:2048
    ds_read_b64_tr_b16 v[160:161], v62 offset:0
    ds_read_b64_tr_b16 v[162:163], v62 offset:2048
    ds_read_b64_tr_b16 v[164:165], v63 offset:0
    ds_read_b64_tr_b16 v[166:167], v63 offset:2048
    s_mul_i32 s47, s46, 98304
    s_add_u32 s47, s47, s44
    s_add_u32 m0, s45, 20480
    s_add_u32 s46, s46, 1
    s_and_b32 s46, s46, 15
    buffer_load_dwordx4 v56, s[48:51], s47 offen offset:0  lds
    buffer_load_dwordx4 v57, s[48:51], s47 offen offset:1024  lds
    buffer_load_dwordx4 v58, s[48:51], s47 offen offset:2048  lds
    buffer_load_dwordx4 v59, s[48:51], s47 offen offset:3072  lds
    ds_read_b64_tr_b16 v[168:169], v60 offset:4096
    ds_read_b64_tr_b16 v[170:171], v60 offset:6144
    ds_read_b64_tr_b16 v[172:173], v61 offset:4096
    ds_read_b64_tr_b16 v[174:175], v61 offset:6144
    ds_read_b64_tr_b16 v[176:177], v62 offset:4096
    ds_read_b64_tr_b16 v[178:179], v62 offset:6144
    ds_read_b64_tr_b16 v[180:181], v63 offset:4096
    ds_read_b64_tr_b16 v[182:183], v63 offset:6144
    s_waitcnt lgkmcnt(8)
    s_mul_i32 s47, s46, 98304
    s_add_u32 s47, s47, s44
    s_add_u32 m0, s45, 0
    s_add_u32 s46, s46, 1
    s_and_b32 s46, s46, 15
    buffer_load_dwordx4 v56, s[48:51], s47 offen offset:0  lds
    buffer_load_dwordx4 v57, s[48:51], s47 offen offset:1024  lds
    buffer_load_dwordx4 v58, s[48:51], s47 offen offset:2048  lds
    buffer_load_dwordx4 v59, s[48:51], s47 offen offset:3072  lds
    s_waitcnt vmcnt(16)
    ds_read_b64_tr_b16 v[184:185], v60 offset:8192
    ds_read_b64_tr_b16 v[186:187], v60 offset:10240
    ds_read_b64_tr_b16 v[188:189], v61 offset:8192
    ds_read_b64_tr_b16 v[190:191], v61 offset:10240
    ds_read_b64_tr_b16 v[192:193], v62 offset:8192
    ds_read_b64_tr_b16 v[194:195], v62 offset:10240
    ds_read_b64_tr_b16 v[196:197], v63 offset:8192
    ds_read_b64_tr_b16 v[198:199], v63 offset:10240
    s_waitcnt lgkmcnt(8)
    s_mul_i32 s47, s46, 98304
    s_add_u32 s47, s47, s44
    s_add_u32 m0, s45, 4096
    s_add_u32 s46, s46, 1
    s_and_b32 s46, s46, 15
    buffer_load_dwordx4 v56, s[48:51], s47 offen offset:0  lds
    buffer_load_dwordx4 v57, s[48:51], s47 offen offset:1024  lds
    buffer_load_dwordx4 v58, s[48:51], s47 offen offset:2048  lds
    buffer_load_dwordx4 v59, s[48:51], s47 offen offset:3072  lds
    s_waitcnt vmcnt(16)
    ds_read_b64_tr_b16 v[200:201], v60 offset:12288
    ds_read_b64_tr_b16 v[202:203], v60 offset:14336
    ds_read_b64_tr_b16 v[204:205], v61 offset:12288
    ds_read_b64_tr_b16 v[206:207], v61 offset:14336
    ds_read_b64_tr_b16 v[208:209], v62 offset:12288
    ds_read_b64_tr_b16 v[210:211], v62 offset:14336
    ds_read_b64_tr_b16 v[212:213], v63 offset:12288
    ds_read_b64_tr_b16 v[214:215], v63 offset:14336
    s_waitcnt lgkmcnt(8)
    s_mul_i32 s47, s46, 98304
    s_add_u32 s47, s47, s44
    s_add_u32 m0, s45, 8192
    s_add_u32 s46, s46, 1
    s_and_b32 s46, s46, 15
    buffer_load_dwordx4 v56, s[48:51], s47 offen offset:0  lds
    buffer_load_dwordx4 v57, s[48:51], s47 offen offset:1024  lds
    buffer_load_dwordx4 v58, s[48:51], s47 offen offset:2048  lds
    buffer_load_dwordx4 v59, s[48:51], s47 offen offset:3072  lds
    s_waitcnt vmcnt(16)
    ds_read_b64_tr_b16 v[216:217], v60 offset:16384
    ds_read_b64_tr_b16 v[218:219], v60 offset:18432
    ds_read_b64_tr_b16 v[220:221], v61 offset:16384
    ds_read_b64_tr_b16 v[222:223], v61 offset:18432
    ds_read_b64_tr_b16 v[224:225], v62 offset:16384
    ds_read_b64_tr_b16 v[226:227], v62 offset:18432
    ds_read_b64_tr_b16 v[228:229], v63 offset:16384
    ds_read_b64_tr_b16 v[230:231], v63 offset:18432
    s_waitcnt lgkmcnt(8)
    s_mul_i32 s47, s46, 98304
    s_add_u32 s47, s47, s44
    s_add_u32 m0, s45, 12288
    s_add_u32 s46, s46, 1
    s_and_b32 s46, s46, 15
    buffer_load_dwordx4 v56, s[48:51], s47 offen offset:0  lds
    buffer_load_dwordx4 v57, s[48:51], s47 offen offset:1024  lds
    buffer_load_dwordx4 v58, s[48:51], s47 offen offset:2048  lds
    buffer_load_dwordx4 v59, s[48:51], s47 offen offset:3072  lds
    v_lshlrev_b32 v7, 4, v2
    buffer_load_dwordx2 v[4:5], v7, s[32:35], s59 offen sc1
    s_waitcnt vmcnt(17)
    ds_read_b64_tr_b16 v[232:233], v60 offset:20480
    ds_read_b64_tr_b16 v[234:235], v60 offset:22528
    ds_read_b64_tr_b16 v[236:237], v61 offset:20480
    ds_read_b64_tr_b16 v[238:239], v61 offset:22528
    ds_read_b64_tr_b16 v[240:241], v62 offset:20480
    ds_read_b64_tr_b16 v[242:243], v62 offset:22528
    ds_read_b64_tr_b16 v[244:245], v63 offset:20480
    ds_read_b64_tr_b16 v[246:247], v63 offset:22528
    s_waitcnt lgkmcnt(8)
    s_mul_i32 s47, s46, 98304
    s_add_u32 s47, s47, s44
    s_add_u32 m0, s45, 16384
    s_add_u32 s46, s46, 1
    s_and_b32 s46, s46, 15
    buffer_load_dwordx4 v56, s[48:51], s47 offen offset:0  lds
    buffer_load_dwordx4 v57, s[48:51], s47 offen offset:1024  lds
    buffer_load_dwordx4 v58, s[48:51], s47 offen offset:2048  lds
    buffer_load_dwordx4 v59, s[48:51], s47 offen offset:3072  lds
    s_waitcnt lgkmcnt(0)
    s_mul_i32 s47, s46, 98304
    s_add_u32 s47, s47, s44
    s_add_u32 m0, s45, 20480
    s_add_u32 s46, s46, 1
    s_and_b32 s46, s46, 15
    buffer_load_dwordx4 v56, s[48:51], s47 offen offset:0  lds
    buffer_load_dwordx4 v57, s[48:51], s47 offen offset:1024  lds
    buffer_load_dwordx4 v58, s[48:51], s47 offen offset:2048  lds
    buffer_load_dwordx4 v59, s[48:51], s47 offen offset:3072  lds
    s_waitcnt vmcnt(8)
    v_cmp_ne_u64 vcc, s[30:31], v[4:5]
    s_lshl_b32 s56, s68, 2
    s_lshr_b64 s[62:63], vcc, s56
    s_sub_u32 s56, 64, s56
    s_lshl_b64 vcc, vcc, s56
    s_or_b64 s[62:63], s[62:63], vcc
    s_mov_b32 s70, 0
FAP_7:
    s_nop 4
    s_and_b32 s56, s62, 0xffff
    s_and_b32 s71, s63, 0x0
    s_or_b32 s56, s56, s71
    s_cbranch_scc0 FAOK_6
    s_add_u32 s70, s70, 1
    s_cmp_gt_u32 s70, 65536
    s_cbranch_scc1 FAOK_6
    s_sleep 2
    buffer_load_dwordx2 v[4:5], v7, s[32:35], s59 offen sc1
    s_waitcnt vmcnt(0)
    v_cmp_ne_u64 vcc, s[30:31], v[4:5]
    s_lshl_b32 s56, s68, 2
    s_lshr_b64 s[62:63], vcc, s56
    s_sub_u32 s56, 64, s56
    s_lshl_b64 vcc, vcc, s56
    s_or_b64 s[62:63], s[62:63], vcc
    s_branch FAP_7
FAOK_6:
    s_nop 4
    s_add_u32 s61, s57, s58
    buffer_load_dwordx4 v[8:11], v64, s[32:35], s61 offen sc1
    buffer_load_dwordx4 v[12:15], v65, s[32:35], s61 offen sc1
    buffer_load_dwordx4 v[16:19], v66, s[32:35], s61 offen sc1
    buffer_load_dwordx4 v[20:23], v67, s[32:35], s61 offen sc1
    s_add_u32 s58, s58, 4096
    s_and_b32 s58, s58, 0xffff
    s_add_u32 s61, s57, s58
    buffer_load_dwordx4 v[24:27], v64, s[32:35], s61 offen sc1
    buffer_load_dwordx4 v[28:31], v65, s[32:35], s61 offen sc1
    buffer_load_dwordx4 v[32:35], v66, s[32:35], s61 offen sc1
    buffer_load_dwordx4 v[36:39], v67, s[32:35], s61 offen sc1
    s_add_u32 s58, s58, 4096
    s_and_b32 s58, s58, 0xffff
    s_add_u32 s61, s57, s58
    buffer_load_dwordx4 v[40:43], v64, s[32:35], s61 offen sc1
    buffer_load_dwordx4 v[44:47], v65, s[32:35], s61 offen sc1
    buffer_load_dwordx4 v[48:51], v66, s[32:35], s61 offen sc1
    buffer_load_dwordx4 v[52:55], v67, s[32:35], s61 offen sc1
    s_add_u32 s58, s58, 4096
    s_and_b32 s58, s58, 0xffff
    s_add_u32 s61, s57, s58
    buffer_load_dwordx4 v[136:139], v64, s[32:35], s61 offen sc1
    buffer_load_dwordx4 v[140:143], v65, s[32:35], s61 offen sc1
    buffer_load_dwordx4 v[144:147], v66, s[32:35], s61 offen sc1
    buffer_load_dwordx4 v[148:151], v67, s[32:35], s61 offen sc1
    s_add_u32 s58, s58, 4096
    s_and_b32 s58, s58, 0xffff
    v_mov_b32 v3, 162072
    v_mov_b32 v6, 1
    s_mov_b32 s70, 0
FAP_9:
    s_nop 4
    s_and_b32 s56, s62, 0xffff0000
    s_and_b32 s71, s63, 0x0
    s_or_b32 s56, s56, s71
    s_cbranch_scc0 FAOK_8
    s_add_u32 s70, s70, 1
    s_cmp_gt_u32 s70, 65536
    s_cbranch_scc1 FAOK_8
    s_sleep 2
    buffer_load_dwordx2 v[4:5], v7, s[32:35], s59 offen sc1
    s_waitcnt vmcnt(0)
    v_cmp_ne_u64 vcc, s[30:31], v[4:5]
    s_lshl_b32 s56, s68, 2
    s_lshr_b64 s[62:63], vcc, s56
    s_sub_u32 s56, 64, s56
    s_lshl_b64 vcc, vcc, s56
    s_or_b64 s[62:63], s[62:63], vcc
    s_branch FAP_9
FAOK_8:
    s_nop 4
    s_waitcnt vmcnt(12)
    v_mfma_f32_16x16x32_bf16 v[72:75], v[152:155], v[8:11], 0
    s_mov_b64 exec, 1
    ds_add_u32 v3, v6
    s_mov_b64 exec, -1
    v_mfma_f32_16x16x32_bf16 v[88:91], v[156:159], v[8:11], 0
    v_mfma_f32_16x16x32_bf16 v[104:107], v[160:163], v[8:11], 0
    v_mfma_f32_16x16x32_bf16 v[120:123], v[164:167], v[8:11], 0
    s_add_u32 s61, s57, s58
    buffer_load_dwordx4 v[8:11], v64, s[32:35], s61 offen sc1
    v_mfma_f32_16x16x32_bf16 v[76:79], v[152:155], v[12:15], 0
    v_mfma_f32_16x16x32_bf16 v[92:95], v[156:159], v[12:15], 0
    v_mfma_f32_16x16x32_bf16 v[108:111], v[160:163], v[12:15], 0
    v_mfma_f32_16x16x32_bf16 v[124:127], v[164:167], v[12:15], 0
    buffer_load_dwordx4 v[12:15], v65, s[32:35], s61 offen sc1
    v_mfma_f32_16x16x32_bf16 v[80:83], v[152:155], v[16:19], 0
    v_mfma_f32_16x16x32_bf16 v[96:99], v[156:159], v[16:19], 0
    v_mfma_f32_16x16x32_bf16 v[112:115], v[160:163], v[16:19], 0
    v_mfma_f32_16x16x32_bf16 v[128:131], v[164:167], v[16:19], 0
    buffer_load_dwordx4 v[16:19], v66, s[32:35], s61 offen sc1
    v_mfma_f32_16x16x32_bf16 v[84:87], v[152:155], v[20:23], 0
    v_mfma_f32_16x16x32_bf16 v[100:103], v[156:159], v[20:23], 0
    v_mfma_f32_16x16x32_bf16 v[116:119], v[160:163], v[20:23], 0
    v_mfma_f32_16x16x32_bf16 v[132:135], v[164:167], v[20:23], 0
    buffer_load_dwordx4 v[20:23], v67, s[32:35], s61 offen sc1
    s_add_u32 s58, s58, 4096
    s_and_b32 s58, s58, 0xffff
    s_waitcnt vmcnt(12)
    v_mfma_f32_16x16x32_bf16 v[72:75], v[168:171], v[24:27], v[72:75]
    ds_read_b64_tr_b16 v[152:153], v60 offset:0
    ds_read_b64_tr_b16 v[154:155], v60 offset:2048
    v_mfma_f32_16x16x32_bf16 v[88:91], v[172:175], v[24:27], v[88:91]
    ds_read_b64_tr_b16 v[156:157], v61 offset:0
    ds_read_b64_tr_b16 v[158:159], v61 offset:2048
    v_mfma_f32_16x16x32_bf16 v[104:107], v[176:179], v[24:27], v[104:107]
    ds_read_b64_tr_b16 v[160:161], v62 offset:0
    ds_read_b64_tr_b16 v[162:163], v62 offset:2048
    v_mfma_f32_16x16x32_bf16 v[120:123], v[180:183], v[24:27], v[120:123]
    s_add_u32 s61, s57, s58
    buffer_load_dwordx4 v[24:27], v64, s[32:35], s61 offen sc1
    v_mfma_f32_16x16x32_bf16 v[76:79], v[168:171], v[28:31], v[76:79]
    ds_read_b64_tr_b16 v[164:165], v63 offset:0
    ds_read_b64_tr_b16 v[166:167], v63 offset:2048
    v_mfma_f32_16x16x32_bf16 v[92:95], v[172:175], v[28:31], v[92:95]
    s_mov_b64 exec, 1
    ds_add_u32 v3, v6
    s_mov_b64 exec, -1
    v_mfma_f32_16x16x32_bf16 v[108:111], v[176:179], v[28:31], v[108:111]
    v_mfma_f32_16x16x32_bf16 v[124:127], v[180:183], v[28:31], v[124:127]
    buffer_load_dwordx4 v[28:31], v65, s[32:35], s61 offen sc1
    v_mfma_f32_16x16x32_bf16 v[80:83], v[168:171], v[32:35], v[80:83]
    v_mfma_f32_16x16x32_bf16 v[96:99], v[172:175], v[32:35], v[96:99]
    v_mfma_f32_16x16x32_bf16 v[112:115], v[176:179], v[32:35], v[112:115]
    v_mfma_f32_16x16x32_bf16 v[128:131], v[180:183], v[32:35], v[128:131]
    buffer_load_dwordx4 v[32:35], v66, s[32:35], s61 offen sc1
    v_mfma_f32_16x16x32_bf16 v[84:87], v[168:171], v[36:39], v[84:87]
    v_mfma_f32_16x16x32_bf16 v[100:103], v[172:175], v[36:39], v[100:103]
    v_mfma_f32_16x16x32_bf16 v[116:119], v[176:179], v[36:39], v[116:119]
    v_mfma_f32_16x16x32_bf16 v[132:135], v[180:183], v[36:39], v[132:135]
    buffer_load_dwordx4 v[36:39], v67, s[32:35], s61 offen sc1
    s_add_u32 s58, s58, 4096
    s_and_b32 s58, s58, 0xffff
    s_waitcnt vmcnt(12)
    v_mfma_f32_16x16x32_bf16 v[72:75], v[184:187], v[40:43], v[72:75]
    s_waitcnt lgkmcnt(1)
    s_mul_i32 s47, s46, 98304
    s_add_u32 s47, s47, s44
    s_add_u32 m0, s45, 0
    s_add_u32 s46, s46, 1
    s_and_b32 s46, s46, 15
    v_mfma_f32_16x16x32_bf16 v[88:91], v[188:191], v[40:43], v[88:91]
    buffer_load_dwordx4 v56, s[48:51], s47 offen offset:0  lds
    v_mfma_f32_16x16x32_bf16 v[104:107], v[192:195], v[40:43], v[104:107]
    buffer_load_dwordx4 v57, s[48:51], s47 offen offset:1024  lds
    v_mfma_f32_16x16x32_bf16 v[120:123], v[196:199], v[40:43], v[120:123]
    s_add_u32 s61, s57, s58
    buffer_load_dwordx4 v[40:43], v64, s[32:35], s61 offen sc1
    v_mfma_f32_16x16x32_bf16 v[76:79], v[184:187], v[44:47], v[76:79]
    buffer_load_dwordx4 v58, s[48:51], s47 offen offset:2048  lds
    v_mfma_f32_16x16x32_bf16 v[92:95], v[188:191], v[44:47], v[92:95]
    buffer_load_dwordx4 v59, s[48:51], s47 offen offset:3072  lds
    v_mfma_f32_16x16x32_bf16 v[108:111], v[192:195], v[44:47], v[108:111]
    ds_read_b64_tr_b16 v[168:169], v60 offset:4096
    ds_read_b64_tr_b16 v[170:171], v60 offset:6144
    v_mfma_f32_16x16x32_bf16 v[124:127], v[196:199], v[44:47], v[124:127]
    buffer_load_dwordx4 v[44:47], v65, s[32:35], s61 offen sc1
    v_mfma_f32_16x16x32_bf16 v[80:83], v[184:187], v[48:51], v[80:83]
    ds_read_b64_tr_b16 v[172:173], v61 offset:4096
    ds_read_b64_tr_b16 v[174:175], v61 offset:6144
    v_mfma_f32_16x16x32_bf16 v[96:99], v[188:191], v[48:51], v[96:99]
    ds_read_b64_tr_b16 v[176:177], v62 offset:4096
    ds_read_b64_tr_b16 v[178:179], v62 offset:6144
    v_mfma_f32_16x16x32_bf16 v[112:115], v[192:195], v[48:51], v[112:115]
    ds_read_b64_tr_b16 v[180:181], v63 offset:4096
    ds_read_b64_tr_b16 v[182:183], v63 offset:6144
    v_mfma_f32_16x16x32_bf16 v[128:131], v[196:199], v[48:51], v[128:131]
    buffer_load_dwordx4 v[48:51], v66, s[32:35], s61 offen sc1
    v_mfma_f32_16x16x32_bf16 v[84:87], v[184:187], v[52:55], v[84:87]
    s_mov_b64 exec, 1
    ds_add_u32 v3, v6
    s_mov_b64 exec, -1
    v_mfma_f32_16x16x32_bf16 v[100:103], v[188:191], v[52:55], v[100:103]
    v_mfma_f32_16x16x32_bf16 v[116:119], v[192:195], v[52:55], v[116:119]
    v_mfma_f32_16x16x32_bf16 v[132:135], v[196:199], v[52:55], v[132:135]
    buffer_load_dwordx4 v[52:55], v67, s[32:35], s61 offen sc1
    s_add_u32 s58, s58, 4096
    s_and_b32 s58, s58, 0xffff
    s_waitcnt vmcnt(16)
    v_mfma_f32_16x16x32_bf16 v[72:75], v[200:203], v[136:139], v[72:75]
    s_waitcnt lgkmcnt(1)
    s_mul_i32 s47, s46, 98304
    s_add_u32 s47, s47, s44
    s_add_u32 m0, s45, 4096
    s_add_u32 s46, s46, 1
    s_and_b32 s46, s46, 15
    v_mfma_f32_16x16x32_bf16 v[88:91], v[204:207], v[136:139], v[88:91]
    buffer_load_dwordx4 v56, s[48:51], s47 offen offset:0  lds
    v_mfma_f32_16x16x32_bf16 v[104:107], v[208:211], v[136:139], v[104:107]
    buffer_load_dwordx4 v57, s[48:51], s47 offen offset:1024  lds
    v_mfma_f32_16x16x32_bf16 v[120:123], v[212:215], v[136:139], v[120:123]
    s_add_u32 s61, s57, s58
    buffer_load_dwordx4 v[136:139], v64, s[32:35], s61 offen sc1
    v_mfma_f32_16x16x32_bf16 v[76:79], v[200:203], v[140:143], v[76:79]
    buffer_load_dwordx4 v58, s[48:51], s47 offen offset:2048  lds
    v_mfma_f32_16x16x32_bf16 v[92:95], v[204:207], v[140:143], v[92:95]
    buffer_load_dwordx4 v59, s[48:51], s47 offen offset:3072  lds
    v_mfma_f32_16x16x32_bf16 v[108:111], v[208:211], v[140:143], v[108:111]
    ds_read_b64_tr_b16 v[184:185], v60 offset:8192
    ds_read_b64_tr_b16 v[186:187], v60 offset:10240
    v_mfma_f32_16x16x32_bf16 v[124:127], v[212:215], v[140:143], v[124:127]
    buffer_load_dwordx4 v[140:143], v65, s[32:35], s61 offen sc1
    v_mfma_f32_16x16x32_bf16 v[80:83], v[200:203], v[144:147], v[80:83]
    ds_read_b64_tr_b16 v[188:189], v61 offset:8192
    ds_read_b64_tr_b16 v[190:191], v61 offset:10240
    v_mfma_f32_16x16x32_bf16 v[96:99], v[204:207], v[144:147], v[96:99]
    ds_read_b64_tr_b16 v[192:193], v62 offset:8192
    ds_read_b64_tr_b16 v[194:195], v62 offset:10240
    v_mfma_f32_16x16x32_bf16 v[112:115], v[208:211], v[144:147], v[112:115]
    ds_read_b64_tr_b16 v[196:197], v63 offset:8192
    ds_read_b64_tr_b16 v[198:199], v63 offset:10240
    v_mfma_f32_16x16x32_bf16 v[128:131], v[212:215], v[144:147], v[128:131]
    buffer_load_dwordx4 v[144:147], v66, s[32:35], s61 offen sc1
    v_mfma_f32_16x16x32_bf16 v[84:87], v[200:203], v[148:151], v[84:87]
    s_mov_b64 exec, 1
    ds_add_u32 v3, v6
    s_mov_b64 exec, -1
    v_mfma_f32_16x16x32_bf16 v[100:103], v[204:207], v[148:151], v[100:103]
    v_mfma_f32_16x16x32_bf16 v[116:119], v[208:211], v[148:151], v[116:119]
    v_mfma_f32_16x16x32_bf16 v[132:135], v[212:215], v[148:151], v[132:135]
    buffer_load_dwordx4 v[148:151], v67, s[32:35], s61 offen sc1
    s_add_u32 s58, s58, 4096
    s_and_b32 s58, s58, 0xffff
    s_mov_b32 s70, 0
FAP_11:
    s_nop 4
    s_and_b32 s56, s62, 0x0
    s_and_b32 s71, s63, 0xffff
    s_or_b32 s56, s56, s71
    s_cbranch_scc0 FAOK_10
    s_add_u32 s70, s70, 1
    s_cmp_gt_u32 s70, 65536
    s_cbranch_scc1 FAOK_10
    s_sleep 2
    buffer_load_dwordx2 v[4:5], v7, s[32:35], s59 offen sc1
    s_waitcnt vmcnt(0)
    v_cmp_ne_u64 vcc, s[30:31], v[4:5]
    s_lshl_b32 s56, s68, 2
    s_lshr_b64 s[62:63], vcc, s56
    s_sub_u32 s56, 64, s56
    s_lshl_b64 vcc, vcc, s56
    s_or_b64 s[62:63], s[62:63], vcc
    s_branch FAP_11
FAOK_10:
    s_nop 4
    s_waitcnt vmcnt(20)
    v_mfma_f32_16x16x32_bf16 v[72:75], v[216:219], v[8:11], v[72:75]
    s_waitcnt lgkmcnt(1)
    s_mul_i32 s47, s46, 98304
    s_add_u32 s47, s47, s44
    s_add_u32 m0, s45, 8192
    s_add_u32 s46, s46, 1
    s_and_b32 s46, s46, 15
    v_mfma_f32_16x16x32_bf16 v[88:91], v[220:223], v[8:11], v[88:91]
    buffer_load_dwordx4 v56, s[48:51], s47 offen offset:0  lds
    v_mfma_f32_16x16x32_bf16 v[104:107], v[224:227], v[8:11], v[104:107]
    buffer_load_dwordx4 v57, s[48:51], s47 offen offset:1024  lds
    v_mfma_f32_16x16x32_bf16 v[120:123], v[228:231], v[8:11], v[120:123]
    s_add_u32 s61, s57, s58
    buffer_load_dwordx4 v[8:11], v64, s[32:35], s61 offen sc1
    v_mfma_f32_16x16x32_bf16 v[76:79], v[216:219], v[12:15], v[76:79]
    buffer_load_dwordx4 v58, s[48:51], s47 offen offset:2048  lds
    v_mfma_f32_16x16x32_bf16 v[92:95], v[220:223], v[12:15], v[92:95]
    buffer_load_dwordx4 v59, s[48:51], s47 offen offset:3072  lds
    v_mfma_f32_16x16x32_bf16 v[108:111], v[224:227], v[12:15], v[108:111]
    ds_read_b64_tr_b16 v[200:201], v60 offset:12288
    ds_read_b64_tr_b16 v[202:203], v60 offset:14336
    v_mfma_f32_16x16x32_bf16 v[124:127], v[228:231], v[12:15], v[124:127]
    buffer_load_dwordx4 v[12:15], v65, s[32:35], s61 offen sc1
    v_mfma_f32_16x16x32_bf16 v[80:83], v[216:219], v[16:19], v[80:83]
    ds_read_b64_tr_b16 v[204:205], v61 offset:12288
    ds_read_b64_tr_b16 v[206:207], v61 offset:14336
    v_mfma_f32_16x16x32_bf16 v[96:99], v[220:223], v[16:19], v[96:99]
    ds_read_b64_tr_b16 v[208:209], v62 offset:12288
    ds_read_b64_tr_b16 v[210:211], v62 offset:14336
    v_mfma_f32_16x16x32_bf16 v[112:115], v[224:227], v[16:19], v[112:115]
    ds_read_b64_tr_b16 v[212:213], v63 offset:12288
    ds_read_b64_tr_b16 v[214:215], v63 offset:14336
    v_mfma_f32_16x16x32_bf16 v[128:131], v[228:231], v[16:19], v[128:131]
    buffer_load_dwordx4 v[16:19], v66, s[32:35], s61 offen sc1
    v_mfma_f32_16x16x32_bf16 v[84:87], v[216:219], v[20:23], v[84:87]
    s_mov_b64 exec, 1
    ds_add_u32 v3, v6
    s_mov_b64 exec, -1
    v_mfma_f32_16x16x32_bf16 v[100:103], v[220:223], v[20:23], v[100:103]
    v_mfma_f32_16x16x32_bf16 v[116:119], v[224:227], v[20:23], v[116:119]
    v_mfma_f32_16x16x32_bf16 v[132:135], v[228:231], v[20:23], v[132:135]
    buffer_load_dwordx4 v[20:23], v67, s[32:35], s61 offen sc1
    s_add_u32 s58, s58, 4096
    s_and_b32 s58, s58, 0xffff
    s_waitcnt vmcnt(24)
    v_mfma_f32_16x16x32_bf16 v[72:75], v[232:235], v[24:27], v[72:75]
    s_waitcnt lgkmcnt(1)
    s_mul_i32 s47, s46, 98304
    s_add_u32 s47, s47, s44
    s_add_u32 m0, s45, 12288
    s_add_u32 s46, s46, 1
    s_and_b32 s46, s46, 15
    v_mfma_f32_16x16x32_bf16 v[88:91], v[236:239], v[24:27], v[88:91]
    buffer_load_dwordx4 v56, s[48:51], s47 offen offset:0  lds
    v_mfma_f32_16x16x32_bf16 v[104:107], v[240:243], v[24:27], v[104:107]
    buffer_load_dwordx4 v57, s[48:51], s47 offen offset:1024  lds
    v_mfma_f32_16x16x32_bf16 v[120:123], v[244:247], v[24:27], v[120:123]
    s_add_u32 s61, s57, s58
    buffer_load_dwordx4 v[24:27], v64, s[32:35], s61 offen sc1
    v_mfma_f32_16x16x32_bf16 v[76:79], v[232:235], v[28:31], v[76:79]
    buffer_load_dwordx4 v58, s[48:51], s47 offen offset:2048  lds
    v_mfma_f32_16x16x32_bf16 v[92:95], v[236:239], v[28:31], v[92:95]
    buffer_load_dwordx4 v59, s[48:51], s47 offen offset:3072  lds
    v_mfma_f32_16x16x32_bf16 v[108:111], v[240:243], v[28:31], v[108:111]
    ds_read_b64_tr_b16 v[216:217], v60 offset:16384
    ds_read_b64_tr_b16 v[218:219], v60 offset:18432
    v_mfma_f32_16x16x32_bf16 v[124:127], v[244:247], v[28:31], v[124:127]
    buffer_load_dwordx4 v[28:31], v65, s[32:35], s61 offen sc1
    v_mfma_f32_16x16x32_bf16 v[80:83], v[232:235], v[32:35], v[80:83]
    ds_read_b64_tr_b16 v[220:221], v61 offset:16384
    ds_read_b64_tr_b16 v[222:223], v61 offset:18432
    v_mfma_f32_16x16x32_bf16 v[96:99], v[236:239], v[32:35], v[96:99]
    ds_read_b64_tr_b16 v[224:225], v62 offset:16384
    ds_read_b64_tr_b16 v[226:227], v62 offset:18432
    v_mfma_f32_16x16x32_bf16 v[112:115], v[240:243], v[32:35], v[112:115]
    ds_read_b64_tr_b16 v[228:229], v63 offset:16384
    ds_read_b64_tr_b16 v[230:231], v63 offset:18432
    v_mfma_f32_16x16x32_bf16 v[128:131], v[244:247], v[32:35], v[128:131]
    buffer_load_dwordx4 v[32:35], v66, s[32:35], s61 offen sc1
    v_mfma_f32_16x16x32_bf16 v[84:87], v[232:235], v[36:39], v[84:87]
    s_mov_b64 exec, 1
    ds_add_u32 v3, v6
    s_mov_b64 exec, -1
    v_mfma_f32_16x16x32_bf16 v[100:103], v[236:239], v[36:39], v[100:103]
    v_mfma_f32_16x16x32_bf16 v[116:119], v[240:243], v[36:39], v[116:119]
    v_mfma_f32_16x16x32_bf16 v[132:135], v[244:247], v[36:39], v[132:135]
    buffer_load_dwordx4 v[36:39], v67, s[32:35], s61 offen sc1
    s_add_u32 s58, s58, 4096
    s_and_b32 s58, s58, 0xffff
    s_waitcnt vmcnt(24)
    v_mfma_f32_16x16x32_bf16 v[72:75], v[152:155], v[40:43], v[72:75]
    ds_read_b64_tr_b16 v[232:233], v60 offset:20480
    ds_read_b64_tr_b16 v[234:235], v60 offset:22528
    v_mfma_f32_16x16x32_bf16 v[88:91], v[156:159], v[40:43], v[88:91]
    ds_read_b64_tr_b16 v[236:237], v61 offset:20480
    ds_read_b64_tr_b16 v[238:239], v61 offset:22528
    v_mfma_f32_16x16x32_bf16 v[104:107], v[160:163], v[40:43], v[104:107]
    ds_read_b64_tr_b16 v[240:241], v62 offset:20480
    ds_read_b64_tr_b16 v[242:243], v62 offset:22528
    v_mfma_f32_16x16x32_bf16 v[120:123], v[164:167], v[40:43], v[120:123]
    s_add_u32 s61, s57, s58
    buffer_load_dwordx4 v[40:43], v64, s[32:35], s61 offen sc1
    v_mfma_f32_16x16x32_bf16 v[76:79], v[152:155], v[44:47], v[76:79]
    ds_read_b64_tr_b16 v[244:245], v63 offset:20480
    ds_read_b64_tr_b16 v[246:247], v63 offset:22528
    v_mfma_f32_16x16x32_bf16 v[92:95], v[156:159], v[44:47], v[92:95]
    s_mov_b64 exec, 1
    ds_add_u32 v3, v6
    s_mov_b64 exec, -1
    v_mfma_f32_16x16x32_bf16 v[108:111], v[160:163], v[44:47], v[108:111]
    v_mfma_f32_16x16x32_bf16 v[124:127], v[164:167], v[44:47], v[124:127]
    buffer_load_dwordx4 v[44:47], v65, s[32:35], s61 offen sc1
    v_mfma_f32_16x16x32_bf16 v[80:83], v[152:155], v[48:51], v[80:83]
    v_mfma_f32_16x16x32_bf16 v[96:99], v[156:159], v[48:51], v[96:99]
    v_mfma_f32_16x16x32_bf16 v[112:115], v[160:163], v[48:51], v[112:115]
    v_mfma_f32_16x16x32_bf16 v[128:131], v[164:167], v[48:51], v[128:131]
    buffer_load_dwordx4 v[48:51], v66, s[32:35], s61 offen sc1
    v_mfma_f32_16x16x32_bf16 v[84:87], v[152:155], v[52:55], v[84:87]
    v_mfma_f32_16x16x32_bf16 v[100:103], v[156:159], v[52:55], v[100:103]
    v_mfma_f32_16x16x32_bf16 v[116:119], v[160:163], v[52:55], v[116:119]
    v_mfma_f32_16x16x32_bf16 v[132:135], v[164:167], v[52:55], v[132:135]
    buffer_load_dwordx4 v[52:55], v67, s[32:35], s61 offen sc1
    s_add_u32 s58, s58, 4096
    s_and_b32 s58, s58, 0xffff
    s_waitcnt vmcnt(20)
    v_mfma_f32_16x16x32_bf16 v[72:75], v[168:171], v[136:139], v[72:75]
    ds_read_b64_tr_b16 v[152:153], v60 offset:0
    ds_read_b64_tr_b16 v[154:155], v60 offset:2048
    v_mfma_f32_16x16x32_bf16 v[88:91], v[172:175], v[136:139], v[88:91]
    ds_read_b64_tr_b16 v[156:157], v61 offset:0
    ds_read_b64_tr_b16 v[158:159], v61 offset:2048
    v_mfma_f32_16x16x32_bf16 v[104:107], v[176:179], v[136:139], v[104:107]
    ds_read_b64_tr_b16 v[160:161], v62 offset:0
    ds_read_b64_tr_b16 v[162:163], v62 offset:2048
    v_mfma_f32_16x16x32_bf16 v[120:123], v[180:183], v[136:139], v[120:123]
    s_add_u32 s61, s57, s58
    buffer_load_dwordx4 v[136:139], v64, s[32:35], s61 offen sc1
    v_mfma_f32_16x16x32_bf16 v[76:79], v[168:171], v[140:143], v[76:79]
    ds_read_b64_tr_b16 v[164:165], v63 offset:0
    ds_read_b64_tr_b16 v[166:167], v63 offset:2048
    v_mfma_f32_16x16x32_bf16 v[92:95], v[172:175], v[140:143], v[92:95]
    s_mov_b64 exec, 1
    ds_add_u32 v3, v6
    s_mov_b64 exec, -1
    v_mfma_f32_16x16x32_bf16 v[108:111], v[176:179], v[140:143], v[108:111]
    v_mfma_f32_16x16x32_bf16 v[124:127], v[180:183], v[140:143], v[124:127]
    buffer_load_dwordx4 v[140:143], v65, s[32:35], s61 offen sc1
    v_mfma_f32_16x16x32_bf16 v[80:83], v[168:171], v[144:147], v[80:83]
    v_mfma_f32_16x16x32_bf16 v[96:99], v[172:175], v[144:147], v[96:99]
    v_mfma_f32_16x16x32_bf16 v[112:115], v[176:179], v[144:147], v[112:115]
    v_mfma_f32_16x16x32_bf16 v[128:131], v[180:183], v[144:147], v[128:131]
    buffer_load_dwordx4 v[144:147], v66, s[32:35], s61 offen sc1
    v_mfma_f32_16x16x32_bf16 v[84:87], v[168:171], v[148:151], v[84:87]
    v_mfma_f32_16x16x32_bf16 v[100:103], v[172:175], v[148:151], v[100:103]
    v_mfma_f32_16x16x32_bf16 v[116:119], v[176:179], v[148:151], v[116:119]
    v_mfma_f32_16x16x32_bf16 v[132:135], v[180:183], v[148:151], v[132:135]
    buffer_load_dwordx4 v[148:151], v67, s[32:35], s61 offen sc1
    s_add_u32 s58, s58, 4096
    s_and_b32 s58, s58, 0xffff
    s_mov_b32 s70, 0
FAP_13:
    s_nop 4
    s_and_b32 s56, s62, 0x0
    s_and_b32 s71, s63, 0xffff0000
    s_or_b32 s56, s56, s71
    s_cbranch_scc0 FAOK_12
    s_add_u32 s70, s70, 1
    s_cmp_gt_u32 s70, 65536
    s_cbranch_scc1 FAOK_12
    s_sleep 2
    buffer_load_dwordx2 v[4:5], v7, s[32:35], s59 offen sc1
    s_waitcnt vmcnt(0)
    v_cmp_ne_u64 vcc, s[30:31], v[4:5]
    s_lshl_b32 s56, s68, 2
    s_lshr_b64 s[62:63], vcc, s56
    s_sub_u32 s56, 64, s56
    s_lshl_b64 vcc, vcc, s56
    s_or_b64 s[62:63], s[62:63], vcc
    s_branch FAP_13
FAOK_12:
    s_nop 4
    s_waitcnt vmcnt(16)
    v_mfma_f32_16x16x32_bf16 v[72:75], v[184:187], v[8:11], v[72:75]
    ds_read_b64_tr_b16 v[168:169], v60 offset:4096
    ds_read_b64_tr_b16 v[170:171], v60 offset:6144
    v_mfma_f32_16x16x32_bf16 v[88:91], v[188:191], v[8:11], v[88:91]
    ds_read_b64_tr_b16 v[172:173], v61 offset:4096
    ds_read_b64_tr_b16 v[174:175], v61 offset:6144
    v_mfma_f32_16x16x32_bf16 v[104:107], v[192:195], v[8:11], v[104:107]
    ds_read_b64_tr_b16 v[176:177], v62 offset:4096
    ds_read_b64_tr_b16 v[178:179], v62 offset:6144
    v_mfma_f32_16x16x32_bf16 v[120:123], v[196:199], v[8:11], v[120:123]
    s_add_u32 s61, s57, s58
    buffer_load_dwordx4 v[8:11], v64, s[32:35], s61 offen sc1
    v_mfma_f32_16x16x32_bf16 v[76:79], v[184:187], v[12:15], v[76:79]
    ds_read_b64_tr_b16 v[180:181], v63 offset:4096
    ds_read_b64_tr_b16 v[182:183], v63 offset:6144
    v_mfma_f32_16x16x32_bf16 v[92:95], v[188:191], v[12:15], v[92:95]
    s_mov_b64 exec, 1
    ds_add_u32 v3, v6
    s_mov_b64 exec, -1
    v_mfma_f32_16x16x32_bf16 v[108:111], v[192:195], v[12:15], v[108:111]
    v_mfma_f32_16x16x32_bf16 v[124:127], v[196:199], v[12:15], v[124:127]
    buffer_load_dwordx4 v[12:15], v65, s[32:35], s61 offen sc1
    v_mfma_f32_16x16x32_bf16 v[80:83], v[184:187], v[16:19], v[80:83]
    v_mfma_f32_16x16x32_bf16 v[96:99], v[188:191], v[16:19], v[96:99]
    v_mfma_f32_16x16x32_bf16 v[112:115], v[192:195], v[16:19], v[112:115]
    v_mfma_f32_16x16x32_bf16 v[128:131], v[196:199], v[16:19], v[128:131]
    buffer_load_dwordx4 v[16:19], v66, s[32:35], s61 offen sc1
    v_mfma_f32_16x16x32_bf16 v[84:87], v[184:187], v[20:23], v[84:87]
    v_mfma_f32_16x16x32_bf16 v[100:103], v[188:191], v[20:23], v[100:103]
    v_mfma_f32_16x16x32_bf16 v[116:119], v[192:195], v[20:23], v[116:119]
    v_mfma_f32_16x16x32_bf16 v[132:135], v[196:199], v[20:23], v[132:135]
    buffer_load_dwordx4 v[20:23], v67, s[32:35], s61 offen sc1
    s_add_u32 s58, s58, 4096
    s_and_b32 s58, s58, 0xffff
    s_waitcnt vmcnt(12)
    v_mfma_f32_16x16x32_bf16 v[72:75], v[200:203], v[24:27], v[72:75]
    ds_read_b64_tr_b16 v[184:185], v60 offset:8192
    ds_read_b64_tr_b16 v[186:187], v60 offset:10240
    v_mfma_f32_16x16x32_bf16 v[88:91], v[204:207], v[24:27], v[88:91]
    ds_read_b64_tr_b16 v[188:189], v61 offset:8192
    ds_read_b64_tr_b16 v[190:191], v61 offset:10240
    v_mfma_f32_16x16x32_bf16 v[104:107], v[208:211], v[24:27], v[104:107]
    ds_read_b64_tr_b16 v[192:193], v62 offset:8192
    ds_read_b64_tr_b16 v[194:195], v62 offset:10240
    v_mfma_f32_16x16x32_bf16 v[120:123], v[212:215], v[24:27], v[120:123]
    s_add_u32 s61, s57, s58
    buffer_load_dwordx4 v[24:27], v64, s[32:35], s61 offen sc1
    v_mfma_f32_16x16x32_bf16 v[76:79], v[200:203], v[28:31], v[76:79]
    ds_read_b64_tr_b16 v[196:197], v63 offset:8192
    ds_read_b64_tr_b16 v[198:199], v63 offset:10240
    v_mfma_f32_16x16x32_bf16 v[92:95], v[204:207], v[28:31], v[92:95]
    s_mov_b64 exec, 1
    ds_add_u32 v3, v6
    s_mov_b64 exec, -1
    v_mfma_f32_16x16x32_bf16 v[108:111], v[208:211], v[28:31], v[108:111]
    v_mfma_f32_16x16x32_bf16 v[124:127], v[212:215], v[28:31], v[124:127]
    buffer_load_dwordx4 v[28:31], v65, s[32:35], s61 offen sc1
    v_mfma_f32_16x16x32_bf16 v[80:83], v[200:203], v[32:35], v[80:83]
    v_mfma_f32_16x16x32_bf16 v[96:99], v[204:207], v[32:35], v[96:99]
    v_mfma_f32_16x16x32_bf16 v[112:115], v[208:211], v[32:35], v[112:115]
    v_mfma_f32_16x16x32_bf16 v[128:131], v[212:215], v[32:35], v[128:131]
    buffer_load_dwordx4 v[32:35], v66, s[32:35], s61 offen sc1
    v_mfma_f32_16x16x32_bf16 v[84:87], v[200:203], v[36:39], v[84:87]
    v_mfma_f32_16x16x32_bf16 v[100:103], v[204:207], v[36:39], v[100:103]
    v_mfma_f32_16x16x32_bf16 v[116:119], v[208:211], v[36:39], v[116:119]
    v_mfma_f32_16x16x32_bf16 v[132:135], v[212:215], v[36:39], v[132:135]
    buffer_load_dwordx4 v[36:39], v67, s[32:35], s61 offen sc1
    s_add_u32 s58, s58, 4096
    s_and_b32 s58, s58, 0xffff
    s_waitcnt vmcnt(12) lgkmcnt(15)
    v_mfma_f32_16x16x32_bf16 v[72:75], v[216:219], v[40:43], v[72:75]
    ds_read_b64_tr_b16 v[200:201], v60 offset:12288
    ds_read_b64_tr_b16 v[202:203], v60 offset:14336
    v_mfma_f32_16x16x32_bf16 v[88:91], v[220:223], v[40:43], v[88:91]
    ds_read_b64_tr_b16 v[204:205], v61 offset:12288
    ds_read_b64_tr_b16 v[206:207], v61 offset:14336
    v_mfma_f32_16x16x32_bf16 v[104:107], v[224:227], v[40:43], v[104:107]
    ds_read_b64_tr_b16 v[208:209], v62 offset:12288
    ds_read_b64_tr_b16 v[210:211], v62 offset:14336
    v_mfma_f32_16x16x32_bf16 v[120:123], v[228:231], v[40:43], v[120:123]
    s_add_u32 s61, s57, s58
    buffer_load_dwordx4 v[40:43], v64, s[32:35], s61 offen sc1
    v_mfma_f32_16x16x32_bf16 v[76:79], v[216:219], v[44:47], v[76:79]
    ds_read_b64_tr_b16 v[212:213], v63 offset:12288
    ds_read_b64_tr_b16 v[214:215], v63 offset:14336
    v_mfma_f32_16x16x32_bf16 v[92:95], v[220:223], v[44:47], v[92:95]
    s_mov_b64 exec, 1
    ds_add_u32 v3, v6
    s_mov_b64 exec, -1
    v_mfma_f32_16x16x32_bf16 v[108:111], v[224:227], v[44:47], v[108:111]
    v_mfma_f32_16x16x32_bf16 v[124:127], v[228:231], v[44:47], v[124:127]
    buffer_load_dwordx4 v[44:47], v65, s[32:35], s61 offen sc1
    v_mfma_f32_16x16x32_bf16 v[80:83], v[216:219], v[48:51], v[80:83]
    v_mfma_f32_16x16x32_bf16 v[96:99], v[220:223], v[48:51], v[96:99]
    v_mfma_f32_16x16x32_bf16 v[112:115], v[224:227], v[48:51], v[112:115]
    v_mfma_f32_16x16x32_bf16 v[128:131], v[228:231], v[48:51], v[128:131]
    buffer_load_dwordx4 v[48:51], v66, s[32:35], s61 offen sc1
    v_mfma_f32_16x16x32_bf16 v[84:87], v[216:219], v[52:55], v[84:87]
    v_mfma_f32_16x16x32_bf16 v[100:103], v[220:223], v[52:55], v[100:103]
    v_mfma_f32_16x16x32_bf16 v[116:119], v[224:227], v[52:55], v[116:119]
    v_mfma_f32_16x16x32_bf16 v[132:135], v[228:231], v[52:55], v[132:135]
    buffer_load_dwordx4 v[52:55], v67, s[32:35], s61 offen sc1
    s_add_u32 s58, s58, 4096
    s_and_b32 s58, s58, 0xffff
    s_waitcnt vmcnt(12)
    v_mfma_f32_16x16x32_bf16 v[72:75], v[232:235], v[136:139], v[72:75]
    s_mov_b64 exec, 1
    ds_add_u32 v3, v6
    s_mov_b64 exec, -1
    v_mfma_f32_16x16x32_bf16 v[88:91], v[236:239], v[136:139], v[88:91]
    s_waitcnt lgkmcnt(2)
    s_lshr_b32 s62, s65, 2
    s_and_b32 s63, s65, 3
    s_lshl_b32 s56, s64, 2
    s_add_u32 s63, s63, s56
    v_lshrrev_b32 v7, 3, v2
    v_lshl_add_u32 v56, v7, 12, v69
    v_add_u32 v57, 31744, v56
    v_add_u32 v58, 63488, v56
    v_add_u32 v59, 95232, v56
    s_mul_i32 s44, s40, 1572864
    s_lshl_b32 s56, s63, 7
    s_add_u32 s44, s44, s56
    s_mov_b32 s46, 0
    s_mov_b32 s68, s46
    s_mov_b32 s48, s22
    s_and_b32 s49, s23, 0xffff
    s_mov_b32 s50, 6291456
    s_mov_b32 s51, 0x00020000
    s_add_u32 s56, s40, 0
    s_and_b32 s56, s56, 3
    v_xor_b32 v7, s56, v70
    v_lshl_add_u32 v60, v7, 5, v71
    s_add_u32 s56, s40, 1
    s_and_b32 s56, s56, 3
    v_xor_b32 v7, s56, v70
    v_lshl_add_u32 v61, v7, 5, v71
    s_add_u32 s56, s40, 2
    s_and_b32 s56, s56, 3
    v_xor_b32 v7, s56, v70
    v_lshl_add_u32 v62, v7, 5, v71
    s_add_u32 s56, s40, 3
    s_and_b32 s56, s56, 3
    v_xor_b32 v7, s56, v70
    v_lshl_add_u32 v63, v7, 5, v71
    v_mfma_f32_16x16x32_bf16 v[104:107], v[240:243], v[136:139], v[104:107]
    v_mfma_f32_16x16x32_bf16 v[120:123], v[244:247], v[136:139], v[120:123]
    s_add_u32 s61, s57, s58
    buffer_load_dwordx4 v[136:139], v64, s[32:35], s61 offen sc1
    v_mfma_f32_16x16x32_bf16 v[76:79], v[232:235], v[140:143], v[76:79]
    v_mfma_f32_16x16x32_bf16 v[92:95], v[236:239], v[140:143], v[92:95]
    v_mfma_f32_16x16x32_bf16 v[108:111], v[240:243], v[140:143], v[108:111]
    v_mfma_f32_16x16x32_bf16 v[124:127], v[244:247], v[140:143], v[124:127]
    buffer_load_dwordx4 v[140:143], v65, s[32:35], s61 offen sc1
    v_mfma_f32_16x16x32_bf16 v[80:83], v[232:235], v[144:147], v[80:83]
    v_mfma_f32_16x16x32_bf16 v[96:99], v[236:239], v[144:147], v[96:99]
    v_mfma_f32_16x16x32_bf16 v[112:115], v[240:243], v[144:147], v[112:115]
    v_mfma_f32_16x16x32_bf16 v[128:131], v[244:247], v[144:147], v[128:131]
    buffer_load_dwordx4 v[144:147], v66, s[32:35], s61 offen sc1
    v_mfma_f32_16x16x32_bf16 v[84:87], v[232:235], v[148:151], v[84:87]
    v_mfma_f32_16x16x32_bf16 v[100:103], v[236:239], v[148:151], v[100:103]
    v_mfma_f32_16x16x32_bf16 v[116:119], v[240:243], v[148:151], v[116:119]
    v_mfma_f32_16x16x32_bf16 v[132:135], v[244:247], v[148:151], v[132:135]
    buffer_load_dwordx4 v[148:151], v67, s[32:35], s61 offen sc1
    s_add_u32 s58, s58, 4096
    s_and_b32 s58, s58, 0xffff
    s_waitcnt vmcnt(12)
    v_mfma_f32_16x16x32_bf16 v[72:75], v[152:155], v[8:11], v[72:75]
    s_mov_b64 exec, 1
    ds_add_u32 v3, v6
    s_mov_b64 exec, -1
    v_mfma_f32_16x16x32_bf16 v[88:91], v[156:159], v[8:11], v[88:91]
    s_lshl_b32 s47, s46, 17
    s_add_u32 s47, s47, s44
    s_add_u32 m0, s45, 12288
    s_add_u32 s46, s46, 1
    v_mfma_f32_16x16x32_bf16 v[104:107], v[160:163], v[8:11], v[104:107]
    buffer_load_dwordx4 v56, s[48:51], s47 offen offset:0  lds
    v_mfma_f32_16x16x32_bf16 v[120:123], v[164:167], v[8:11], v[120:123]
    v_mfma_f32_16x16x32_bf16 v[76:79], v[152:155], v[12:15], v[76:79]
    buffer_load_dwordx4 v57, s[48:51], s47 offen offset:1024  lds
    v_mfma_f32_16x16x32_bf16 v[92:95], v[156:159], v[12:15], v[92:95]
    buffer_load_dwordx4 v58, s[48:51], s47 offen offset:2048  lds
    v_mfma_f32_16x16x32_bf16 v[108:111], v[160:163], v[12:15], v[108:111]
    buffer_load_dwordx4 v59, s[48:51], s47 offen offset:3072  lds
    v_mfma_f32_16x16x32_bf16 v[124:127], v[164:167], v[12:15], v[124:127]
    v_mfma_f32_16x16x32_bf16 v[80:83], v[152:155], v[16:19], v[80:83]
    v_mfma_f32_16x16x32_bf16 v[96:99], v[156:159], v[16:19], v[96:99]
    v_mfma_f32_16x16x32_bf16 v[112:115], v[160:163], v[16:19], v[112:115]
    v_mfma_f32_16x16x32_bf16 v[128:131], v[164:167], v[16:19], v[128:131]
    v_mfma_f32_16x16x32_bf16 v[84:87], v[152:155], v[20:23], v[84:87]
    v_mfma_f32_16x16x32_bf16 v[100:103], v[156:159], v[20:23], v[100:103]
    v_mfma_f32_16x16x32_bf16 v[116:119], v[160:163], v[20:23], v[116:119]
    v_mfma_f32_16x16x32_bf16 v[132:135], v[164:167], v[20:23], v[132:135]
    s_waitcnt vmcnt(12)
    v_mfma_f32_16x16x32_bf16 v[72:75], v[168:171], v[24:27], v[72:75]
    s_mov_b64 exec, 1
    ds_add_u32 v3, v6
    s_mov_b64 exec, -1
    v_mfma_f32_16x16x32_bf16 v[88:91], v[172:175], v[24:27], v[88:91]
    s_lshl_b32 s47, s46, 17
    s_add_u32 s47, s47, s44
    s_add_u32 m0, s45, 16384
    s_add_u32 s46, s46, 1
    v_mfma_f32_16x16x32_bf16 v[104:107], v[176:179], v[24:27], v[104:107]
    buffer_load_dwordx4 v56, s[48:51], s47 offen offset:0  lds
    v_mfma_f32_16x16x32_bf16 v[120:123], v[180:183], v[24:27], v[120:123]
    v_mfma_f32_16x16x32_bf16 v[76:79], v[168:171], v[28:31], v[76:79]
    buffer_load_dwordx4 v57, s[48:51], s47 offen offset:1024  lds
    v_mfma_f32_16x16x32_bf16 v[92:95], v[172:175], v[28:31], v[92:95]
    buffer_load_dwordx4 v58, s[48:51], s47 offen offset:2048  lds
    v_mfma_f32_16x16x32_bf16 v[108:111], v[176:179], v[28:31], v[108:111]
    buffer_load_dwordx4 v59, s[48:51], s47 offen offset:3072  lds
    v_mfma_f32_16x16x32_bf16 v[124:127], v[180:183], v[28:31], v[124:127]
    v_mfma_f32_16x16x32_bf16 v[80:83], v[168:171], v[32:35], v[80:83]
    v_mfma_f32_16x16x32_bf16 v[96:99], v[172:175], v[32:35], v[96:99]
    v_mfma_f32_16x16x32_bf16 v[112:115], v[176:179], v[32:35], v[112:115]
    v_mfma_f32_16x16x32_bf16 v[128:131], v[180:183], v[32:35], v[128:131]
    v_mfma_f32_16x16x32_bf16 v[84:87], v[168:171], v[36:39], v[84:87]
    v_mfma_f32_16x16x32_bf16 v[100:103], v[172:175], v[36:39], v[100:103]
    v_mfma_f32_16x16x32_bf16 v[116:119], v[176:179], v[36:39], v[116:119]
    v_mfma_f32_16x16x32_bf16 v[132:135], v[180:183], v[36:39], v[132:135]
    s_waitcnt vmcnt(12)
    v_mfma_f32_16x16x32_bf16 v[72:75], v[184:187], v[40:43], v[72:75]
    s_mov_b64 exec, 1
    ds_add_u32 v3, v6
    s_mov_b64 exec, -1
    v_mfma_f32_16x16x32_bf16 v[88:91], v[188:191], v[40:43], v[88:91]
    s_lshl_b32 s47, s46, 17
    s_add_u32 s47, s47, s44
    s_add_u32 m0, s45, 20480
    s_add_u32 s46, s46, 1
    v_mfma_f32_16x16x32_bf16 v[104:107], v[192:195], v[40:43], v[104:107]
    buffer_load_dwordx4 v56, s[48:51], s47 offen offset:0  lds
    v_mfma_f32_16x16x32_bf16 v[120:123], v[196:199], v[40:43], v[120:123]
    v_mfma_f32_16x16x32_bf16 v[76:79], v[184:187], v[44:47], v[76:79]
    buffer_load_dwordx4 v57, s[48:51], s47 offen offset:1024  lds
    v_mfma_f32_16x16x32_bf16 v[92:95], v[188:191], v[44:47], v[92:95]
    buffer_load_dwordx4 v58, s[48:51], s47 offen offset:2048  lds
    v_mfma_f32_16x16x32_bf16 v[108:111], v[192:195], v[44:47], v[108:111]
    buffer_load_dwordx4 v59, s[48:51], s47 offen offset:3072  lds
    v_mfma_f32_16x16x32_bf16 v[124:127], v[196:199], v[44:47], v[124:127]
    v_mfma_f32_16x16x32_bf16 v[80:83], v[184:187], v[48:51], v[80:83]
    v_mfma_f32_16x16x32_bf16 v[96:99], v[188:191], v[48:51], v[96:99]
    v_mfma_f32_16x16x32_bf16 v[112:115], v[192:195], v[48:51], v[112:115]
    v_mfma_f32_16x16x32_bf16 v[128:131], v[196:199], v[48:51], v[128:131]
    v_mfma_f32_16x16x32_bf16 v[84:87], v[184:187], v[52:55], v[84:87]
    v_mfma_f32_16x16x32_bf16 v[100:103], v[188:191], v[52:55], v[100:103]
    v_mfma_f32_16x16x32_bf16 v[116:119], v[192:195], v[52:55], v[116:119]
    v_mfma_f32_16x16x32_bf16 v[132:135], v[196:199], v[52:55], v[132:135]
    s_waitcnt vmcnt(12)
    v_add_u32 v4, s45, v68
    v_mfma_f32_16x16x32_bf16 v[76:79], v[200:203], v[140:143], v[76:79]
    s_mov_b64 exec, 1
    ds_add_u32 v3, v6
    s_mov_b64 exec, -1
    v_mfma_f32_16x16x32_bf16 v[92:95], v[204:207], v[140:143], v[92:95]
    v_mfma_f32_16x16x32_bf16 v[108:111], v[208:211], v[140:143], v[108:111]
    v_mfma_f32_16x16x32_bf16 v[124:127], v[212:215], v[140:143], v[124:127]
    v_mfma_f32_16x16x32_bf16 v[80:83], v[200:203], v[144:147], v[80:83]
    v_mfma_f32_16x16x32_bf16 v[96:99], v[204:207], v[144:147], v[96:99]
    v_mfma_f32_16x16x32_bf16 v[112:115], v[208:211], v[144:147], v[112:115]
    v_mfma_f32_16x16x32_bf16 v[128:131], v[212:215], v[144:147], v[128:131]
    v_mfma_f32_16x16x32_bf16 v[84:87], v[200:203], v[148:151], v[84:87]
    ds_write_b128 v4, v[76:79] offset:0
    v_mfma_f32_16x16x32_bf16 v[100:103], v[204:207], v[148:151], v[100:103]
    ds_write_b128 v4, v[92:95] offset:1024
    v_mfma_f32_16x16x32_bf16 v[116:119], v[208:211], v[148:151], v[116:119]
    ds_write_b128 v4, v[108:111] offset:2048
    v_mfma_f32_16x16x32_bf16 v[132:135], v[212:215], v[148:151], v[132:135]
    ds_write_b128 v4, v[124:127] offset:3072
    v_mfma_f32_16x16x32_bf16 v[72:75], v[200:203], v[136:139], v[72:75]
    ds_write_b128 v4, v[80:83] offset:4096
    v_mfma_f32_16x16x32_bf16 v[88:91], v[204:207], v[136:139], v[88:91]
    ds_write_b128 v4, v[96:99] offset:5120
    v_mfma_f32_16x16x32_bf16 v[104:107], v[208:211], v[136:139], v[104:107]
    ds_write_b128 v4, v[112:115] offset:6144
    v_mfma_f32_16x16x32_bf16 v[120:123], v[212:215], v[136:139], v[120:123]
    ds_write_b128 v4, v[128:131] offset:7168
    ds_write_b128 v4, v[84:87] offset:8192
    ds_write_b128 v4, v[100:103] offset:9216
    ds_write_b128 v4, v[116:119] offset:10240
    ds_write_b128 v4, v[132:135] offset:11264
    s_sub_u32 s56, s40, 1
    s_and_b32 s56, s56, 3
    s_mul_i32 s56, s56, 24576
    v_add_u32 v5, s56, v68
    s_sub_u32 s56, s40, 2
    s_and_b32 s56, s56, 3
    s_mul_i32 s56, s56, 24576
    v_add_u32 v6, s56, v68
    s_sub_u32 s56, s40, 3
    s_and_b32 s56, s56, 3
    s_mul_i32 s56, s56, 24576
    v_add_u32 v7, s56, v68
    s_lshl_b32 s56, s66, 2
    s_add_u32 s56, s56, s40
    s_mul_i32 s57, s56, 205
    s_lshr_b32 s57, s57, 10
    s_mul_i32 s58, s57, 5
    s_sub_u32 s58, s56, s58
    s_mul_i32 s57, s57, 48
    s_lshl_b32 s59, s67, 1
    s_add_u32 s57, s57, s59
    s_mul_i32 s57, s57, 5
    s_add_u32 s57, s57, s58
    s_lshl_b32 s57, s57, 10
    s_add_u32 s57, s57, 8060928
    s_add_u32 s58, s57, 5120
    s_mul_i32 s59, s56, 24
    s_add_u32 s59, s59, s67
    s_mul_i32 s59, s59, 64
    s_add_u32 s59, s59, 4096
    s_mov_b32 s60, 0xbdd2d3e8
    v_lshlrev_b32 v136, 16, v248
    v_and_b32 v137, 0xffff0000, v248
    v_lshlrev_b32 v138, 16, v249
    v_and_b32 v139, 0xffff0000, v249
    v_lshlrev_b32 v140, 16, v250
    v_and_b32 v141, 0xffff0000, v250
    v_lshlrev_b32 v142, 16, v251
    v_and_b32 v143, 0xffff0000, v251
    v_lshlrev_b32 v144, 16, v252
    v_and_b32 v145, 0xffff0000, v252
    v_lshlrev_b32 v146, 16, v253
    v_and_b32 v147, 0xffff0000, v253
    v_lshlrev_b32 v148, 16, v254
    v_and_b32 v149, 0xffff0000, v254
    v_lshlrev_b32 v150, 16, v255
    v_and_b32 v151, 0xffff0000, v255
    v_mov_b32 v3, 162048
    v_mov_b32 v4, 1
    s_waitcnt lgkmcnt(0)
    s_mov_b64 exec, 1
    ds_add_u32 v3, v4
    s_mov_b64 exec, -1
    s_waitcnt vmcnt(8)
    ds_read_b64_tr_b16 v[176:177], v60 offset:12288
    ds_read_b64_tr_b16 v[178:179], v60 offset:14336
    ds_read_b64_tr_b16 v[180:181], v61 offset:12288
    ds_read_b64_tr_b16 v[182:183], v61 offset:14336
    ds_read_b64_tr_b16 v[184:185], v62 offset:12288
    ds_read_b64_tr_b16 v[186:187], v62 offset:14336
    ds_read_b64_tr_b16 v[188:189], v63 offset:12288
    ds_read_b64_tr_b16 v[190:191], v63 offset:14336
    s_waitcnt vmcnt(4)
    ds_read_b64_tr_b16 v[192:193], v60 offset:16384
    ds_read_b64_tr_b16 v[194:195], v60 offset:18432
    ds_read_b64_tr_b16 v[196:197], v61 offset:16384
    ds_read_b64_tr_b16 v[198:199], v61 offset:18432
    ds_read_b64_tr_b16 v[200:201], v62 offset:16384
    ds_read_b64_tr_b16 v[202:203], v62 offset:18432
    ds_read_b64_tr_b16 v[204:205], v63 offset:16384
    ds_read_b64_tr_b16 v[206:207], v63 offset:18432
    s_waitcnt vmcnt(0)
    ds_read_b64_tr_b16 v[208:209], v60 offset:20480
    ds_read_b64_tr_b16 v[210:211], v60 offset:22528
    ds_read_b64_tr_b16 v[212:213], v61 offset:20480
    ds_read_b64_tr_b16 v[214:215], v61 offset:22528
    ds_read_b64_tr_b16 v[216:217], v62 offset:20480
    ds_read_b64_tr_b16 v[218:219], v62 offset:22528
    ds_read_b64_tr_b16 v[220:221], v63 offset:20480
    ds_read_b64_tr_b16 v[222:223], v63 offset:22528
    v_mov_b32 v3, 162048
    s_mov_b32 s70, 0
LW_14:
    s_nop 4
    ds_read_b32 v4, v3
    s_add_u32 s70, s70, 1
    s_waitcnt lgkmcnt(0)
    v_readfirstlane_b32 s71, v4
    s_cmp_gt_u32 s70, 262144
    s_cbranch_scc1 LWX_15
    s_cmp_ge_u32 s71, 4
    s_cbranch_scc1 LWX_15
    s_branch LW_14
LWX_15:
    s_nop 4
    ds_read_b128 v[8:11], v5 offset:0
    ds_read_b128 v[12:15], v5 offset:1024
    ds_read_b128 v[16:19], v5 offset:2048
    ds_read_b128 v[20:23], v5 offset:3072
    ds_read_b128 v[24:27], v6 offset:4096
    ds_read_b128 v[28:31], v6 offset:5120
    ds_read_b128 v[32:35], v6 offset:6144
    ds_read_b128 v[36:39], v6 offset:7168
    ds_read_b128 v[40:43], v7 offset:8192
    ds_read_b128 v[44:47], v7 offset:9216
    ds_read_b128 v[48:51], v7 offset:10240
    ds_read_b128 v[52:55], v7 offset:11264
    s_lshl_b32 s47, s46, 17
    s_add_u32 s47, s47, s44
    s_add_u32 m0, s45, 12288
    s_add_u32 s46, s46, 1
    buffer_load_dwordx4 v56, s[48:51], s47 offen offset:0  lds
    buffer_load_dwordx4 v57, s[48:51], s47 offen offset:1024  lds
    buffer_load_dwordx4 v58, s[48:51], s47 offen offset:2048  lds
    buffer_load_dwordx4 v59, s[48:51], s47 offen offset:3072  lds
    s_lshl_b32 s47, s46, 17
    s_add_u32 s47, s47, s44
    s_add_u32 m0, s45, 16384
    s_add_u32 s46, s46, 1
    buffer_load_dwordx4 v56, s[48:51], s47 offen offset:0  lds
    buffer_load_dwordx4 v57, s[48:51], s47 offen offset:1024  lds
    buffer_load_dwordx4 v58, s[48:51], s47 offen offset:2048  lds
    buffer_load_dwordx4 v59, s[48:51], s47 offen offset:3072  lds
    s_lshl_b32 s47, s46, 17
    s_add_u32 s47, s47, s44
    s_add_u32 m0, s45, 20480
    s_add_u32 s46, s46, 1
    buffer_load_dwordx4 v56, s[48:51], s47 offen offset:0  lds
    buffer_load_dwordx4 v57, s[48:51], s47 offen offset:1024  lds
    buffer_load_dwordx4 v58, s[48:51], s47 offen offset:2048  lds
    buffer_load_dwordx4 v59, s[48:51], s47 offen offset:3072  lds
    v_mov_b32 v84, 0xc0135761
    s_waitcnt lgkmcnt(8)
    v_pk_add_f32 v[152:153], v[72:73], v[8:9]
    v_pk_add_f32 v[154:155], v[74:75], v[10:11]
    v_pk_add_f32 v[156:157], v[88:89], v[12:13]
    v_pk_add_f32 v[158:159], v[90:91], v[14:15]
    v_pk_add_f32 v[160:161], v[104:105], v[16:17]
    v_pk_add_f32 v[162:163], v[106:107], v[18:19]
    v_pk_add_f32 v[164:165], v[120:121], v[20:21]
    v_pk_add_f32 v[166:167], v[122:123], v[22:23]
    s_waitcnt lgkmcnt(4)
    v_pk_add_f32 v[152:153], v[152:153], v[24:25]
    v_pk_add_f32 v[154:155], v[154:155], v[26:27]
    v_pk_add_f32 v[156:157], v[156:157], v[28:29]
    v_pk_add_f32 v[158:159], v[158:159], v[30:31]
    v_pk_add_f32 v[160:161], v[160:161], v[32:33]
    v_pk_add_f32 v[162:163], v[162:163], v[34:35]
    v_pk_add_f32 v[164:165], v[164:165], v[36:37]
    v_pk_add_f32 v[166:167], v[166:167], v[38:39]
    s_waitcnt lgkmcnt(0)
    v_pk_add_f32 v[152:153], v[152:153], v[40:41]
    v_pk_add_f32 v[154:155], v[154:155], v[42:43]
    v_pk_add_f32 v[156:157], v[156:157], v[44:45]
    v_pk_add_f32 v[158:159], v[158:159], v[46:47]
    v_pk_add_f32 v[160:161], v[160:161], v[48:49]
    v_pk_add_f32 v[162:163], v[162:163], v[50:51]
    v_pk_add_f32 v[164:165], v[164:165], v[52:53]
    v_pk_add_f32 v[166:167], v[166:167], v[54:55]
    v_mov_b32 v3, 162052
    v_mov_b32 v85, 1
    s_waitcnt lgkmcnt(0)
    s_mov_b64 exec, 1
    ds_add_u32 v3, v85
    s_mov_b64 exec, -1
    v_cvt_pk_bf16_f32 v76, v152, v153
    v_cvt_pk_bf16_f32 v77, v154, v155
    v_cvt_pk_bf16_f32 v78, v156, v157
    v_cvt_pk_bf16_f32 v79, v158, v159
    v_cvt_pk_bf16_f32 v80, v160, v161
    v_cvt_pk_bf16_f32 v81, v162, v163
    v_cvt_pk_bf16_f32 v82, v164, v165
    v_cvt_pk_bf16_f32 v83, v166, v167
    v_lshlrev_b32 v152, 16, v76
    v_and_b32 v153, 0xffff0000, v76
    v_lshlrev_b32 v154, 16, v77
    v_and_b32 v155, 0xffff0000, v77
    v_lshlrev_b32 v156, 16, v78
    v_and_b32 v157, 0xffff0000, v78
    v_lshlrev_b32 v158, 16, v79
    v_and_b32 v159, 0xffff0000, v79
    v_lshlrev_b32 v160, 16, v80
    v_and_b32 v161, 0xffff0000, v80
    v_lshlrev_b32 v162, 16, v81
    v_and_b32 v163, 0xffff0000, v81
    v_lshlrev_b32 v164, 16, v82
    v_and_b32 v165, 0xffff0000, v82
    v_lshlrev_b32 v166, 16, v83
    v_and_b32 v167, 0xffff0000, v83
    v_pk_add_f32 v[152:153], v[152:153], v[136:137]
    v_pk_add_f32 v[154:155], v[154:155], v[138:139]
    v_pk_add_f32 v[156:157], v[156:157], v[140:141]
    v_pk_add_f32 v[158:159], v[158:159], v[142:143]
    v_pk_add_f32 v[160:161], v[160:161], v[144:145]
    v_pk_add_f32 v[162:163], v[162:163], v[146:147]
    v_pk_add_f32 v[164:165], v[164:165], v[148:149]
    v_pk_add_f32 v[166:167], v[166:167], v[150:151]
    v_cvt_pk_bf16_f32 v76, v152, v153
    v_cvt_pk_bf16_f32 v77, v154, v155
    v_cvt_pk_bf16_f32 v78, v156, v157
    v_cvt_pk_bf16_f32 v79, v158, v159
    v_cvt_pk_bf16_f32 v80, v160, v161
    v_cvt_pk_bf16_f32 v81, v162, v163
    v_cvt_pk_bf16_f32 v82, v164, v165
    v_cvt_pk_bf16_f32 v83, v166, v167
    v_lshlrev_b32 v152, 16, v76
    v_and_b32 v153, 0xffff0000, v76
    v_lshlrev_b32 v154, 16, v77
    v_and_b32 v155, 0xffff0000, v77
    v_lshlrev_b32 v156, 16, v78
    v_and_b32 v157, 0xffff0000, v78
    v_lshlrev_b32 v158, 16, v79
    v_and_b32 v159, 0xffff0000, v79
    v_lshlrev_b32 v160, 16, v80
    v_and_b32 v161, 0xffff0000, v80
    v_lshlrev_b32 v162, 16, v81
    v_and_b32 v163, 0xffff0000, v81
    v_lshlrev_b32 v164, 16, v82
    v_and_b32 v165, 0xffff0000, v82
    v_lshlrev_b32 v166, 16, v83
    v_and_b32 v167, 0xffff0000, v83
    v_pk_mul_f32 v[136:137], v[152:153], v[152:153]
    v_pk_mul_f32 v[138:139], v[154:155], v[154:155]
    v_pk_mul_f32 v[140:141], v[156:157], v[156:157]
    v_pk_mul_f32 v[142:143], v[158:159], v[158:159]
    v_fma_f32 v136, v136, s60, v84
    v_fma_f32 v137, v137, s60, v84
    v_fma_f32 v138, v138, s60, v84
    v_fma_f32 v139, v139, s60, v84
    v_fma_f32 v140, v140, s60, v84
    v_fma_f32 v141, v141, s60, v84
    v_fma_f32 v142, v142, s60, v84
    v_fma_f32 v143, v143, s60, v84
    v_pk_mul_f32 v[136:137], v[136:137], v[152:153]
    v_pk_mul_f32 v[138:139], v[138:139], v[154:155]
    v_pk_mul_f32 v[140:141], v[140:141], v[156:157]
    v_pk_mul_f32 v[142:143], v[142:143], v[158:159]
    v_exp_f32 v136, v136
    v_exp_f32 v137, v137
    v_exp_f32 v138, v138
    v_exp_f32 v139, v139
    v_exp_f32 v140, v140
    v_exp_f32 v141, v141
    v_exp_f32 v142, v142
    v_exp_f32 v143, v143
    v_add_f32 v136, 1.0, v136
    v_add_f32 v137, 1.0, v137
    v_add_f32 v138, 1.0, v138
    v_add_f32 v139, 1.0, v139
    v_add_f32 v140, 1.0, v140
    v_add_f32 v141, 1.0, v141
    v_add_f32 v142, 1.0, v142
    v_add_f32 v143, 1.0, v143
    v_rcp_f32 v136, v136
    v_rcp_f32 v137, v137
    v_rcp_f32 v138, v138
    v_rcp_f32 v139, v139
    v_rcp_f32 v140, v140
    v_rcp_f32 v141, v141
    v_rcp_f32 v142, v142
    v_rcp_f32 v143, v143
    v_pk_mul_f32 v[152:153], v[152:153], v[136:137]
    v_pk_mul_f32 v[154:155], v[154:155], v[138:139]
    v_pk_mul_f32 v[156:157], v[156:157], v[140:141]
    v_pk_mul_f32 v[158:159], v[158:159], v[142:143]
    v_cvt_pk_bf16_f32 v168, v152, v153
    v_cvt_pk_bf16_f32 v169, v154, v155
    v_cvt_pk_bf16_f32 v170, v156, v157
    v_cvt_pk_bf16_f32 v171, v158, v159
    buffer_store_dwordx4 v[168:171], v68, s[32:35], s57 offen sc1
    v_pk_mul_f32 v[144:145], v[160:161], v[160:161]
    v_pk_mul_f32 v[146:147], v[162:163], v[162:163]
    v_pk_mul_f32 v[148:149], v[164:165], v[164:165]
    v_pk_mul_f32 v[150:151], v[166:167], v[166:167]
    v_fma_f32 v144, v144, s60, v84
    v_fma_f32 v145, v145, s60, v84
    v_fma_f32 v146, v146, s60, v84
    v_fma_f32 v147, v147, s60, v84
    v_fma_f32 v148, v148, s60, v84
    v_fma_f32 v149, v149, s60, v84
    v_fma_f32 v150, v150, s60, v84
    v_fma_f32 v151, v151, s60, v84
    v_pk_mul_f32 v[144:145], v[144:145], v[160:161]
    v_pk_mul_f32 v[146:147], v[146:147], v[162:163]
    v_pk_mul_f32 v[148:149], v[148:149], v[164:165]
    v_pk_mul_f32 v[150:151], v[150:151], v[166:167]
    v_exp_f32 v144, v144
    v_exp_f32 v145, v145
    v_exp_f32 v146, v146
    v_exp_f32 v147, v147
    v_exp_f32 v148, v148
    v_exp_f32 v149, v149
    v_exp_f32 v150, v150
    v_exp_f32 v151, v151
    v_add_f32 v144, 1.0, v144
    v_add_f32 v145, 1.0, v145
    v_add_f32 v146, 1.0, v146
    v_add_f32 v147, 1.0, v147
    v_add_f32 v148, 1.0, v148
    v_add_f32 v149, 1.0, v149
    v_add_f32 v150, 1.0, v150
    v_add_f32 v151, 1.0, v151
    v_rcp_f32 v144, v144
    v_rcp_f32 v145, v145
    v_rcp_f32 v146, v146
    v_rcp_f32 v147, v147
    v_rcp_f32 v148, v148
    v_rcp_f32 v149, v149
    v_rcp_f32 v150, v150
    v_rcp_f32 v151, v151
    v_pk_mul_f32 v[160:161], v[160:161], v[144:145]
    v_pk_mul_f32 v[162:163], v[162:163], v[146:147]
    v_pk_mul_f32 v[164:165], v[164:165], v[148:149]
    v_pk_mul_f32 v[166:167], v[166:167], v[150:151]
    v_cvt_pk_bf16_f32 v172, v160, v161
    v_cvt_pk_bf16_f32 v173, v162, v163
    v_cvt_pk_bf16_f32 v174, v164, v165
    v_cvt_pk_bf16_f32 v175, v166, v167
    buffer_store_dwordx4 v[172:175], v68, s[32:35], s58 offen sc1
    v_mov_b32 v3, 162084
    v_mov_b32 v4, 1
    s_mov_b64 exec, 1
    ds_add_u32 v3, v4
    s_mov_b64 exec, -1
    s_waitcnt vmcnt(10)
    ds_read_b64_tr_b16 v[224:225], v60 offset:12288
    ds_read_b64_tr_b16 v[226:227], v60 offset:14336
    ds_read_b64_tr_b16 v[228:229], v61 offset:12288
    ds_read_b64_tr_b16 v[230:231], v61 offset:14336
    ds_read_b64_tr_b16 v[232:233], v62 offset:12288
    ds_read_b64_tr_b16 v[234:235], v62 offset:14336
    ds_read_b64_tr_b16 v[236:237], v63 offset:12288
    ds_read_b64_tr_b16 v[238:239], v63 offset:14336
    s_waitcnt vmcnt(6)
    ds_read_b64_tr_b16 v[240:241], v60 offset:16384
    ds_read_b64_tr_b16 v[242:243], v60 offset:18432
    ds_read_b64_tr_b16 v[244:245], v61 offset:16384
    ds_read_b64_tr_b16 v[246:247], v61 offset:18432
    ds_read_b64_tr_b16 v[248:249], v62 offset:16384
    ds_read_b64_tr_b16 v[250:251], v62 offset:18432
    ds_read_b64_tr_b16 v[252:253], v63 offset:16384
    ds_read_b64_tr_b16 v[254:255], v63 offset:18432
    s_waitcnt vmcnt(0)
    v_mov_b32 v4, s30
    v_mov_b32 v5, s31
    v_mov_b32 v6, 0
    s_mov_b64 exec, 1
    buffer_store_dwordx2 v[4:5], v6, s[32:35], s59 offen sc1
    s_mov_b64 exec, -1
    v_mov_b32 v3, 162100
    v_mov_b32 v7, 1
    s_waitcnt lgkmcnt(0)
    s_mov_b64 exec, 1
    ds_add_u32 v3, v7
    s_mov_b64 exec, -1
    s_or_b32 s56, s2, s40
    s_cmp_lg_u32 s56, 0
    s_cbranch_scc1 KF_NOEP
    s_mov_b32 s56, 0
    v_mov_b32 v4, s30
    v_mov_b32 v5, s31
    v_mov_b32 v6, 0
    s_mov_b64 exec, 1
    buffer_store_dwordx2 v[4:5], v6, s[32:35], s56 offen sc1
    s_mov_b64 exec, -1
KF_NOEP:
    s_nop 4
    v_mov_b32 v3, 162100
    s_mov_b32 s70, 0
LW_16:
    s_nop 4
    ds_read_b32 v4, v3
    s_add_u32 s70, s70, 1
    s_waitcnt lgkmcnt(0)
    v_readfirstlane_b32 s71, v4
    s_cmp_gt_u32 s70, 262144
    s_cbranch_scc1 LWX_17
    s_cmp_ge_u32 s71, 4
    s_cbranch_scc1 LWX_17
    s_branch LW_16
LWX_17:
    s_nop 4
    s_branch KF_G2B
KF_G2:
    s_nop 4
    s_lshr_b32 s62, s65, 2
    s_and_b32 s63, s65, 3
    s_lshl_b32 s56, s64, 2
    s_add_u32 s63, s63, s56
    v_lshrrev_b32 v7, 3, v2
    v_lshl_add_u32 v56, v7, 12, v69
    v_add_u32 v57, 31744, v56
    v_add_u32 v58, 63488, v56
    v_add_u32 v59, 95232, v56
    s_mul_i32 s44, s40, 1572864
    s_lshl_b32 s56, s63, 7
    s_add_u32 s44, s44, s56
    s_mov_b32 s46, 0
    s_mov_b32 s68, s46
    s_mov_b32 s48, s22
    s_and_b32 s49, s23, 0xffff
    s_mov_b32 s50, 6291456
    s_mov_b32 s51, 0x00020000
    s_add_u32 s56, s40, 0
    s_and_b32 s56, s56, 3
    v_xor_b32 v7, s56, v70
    v_lshl_add_u32 v60, v7, 5, v71
    s_add_u32 s56, s40, 1
    s_and_b32 s56, s56, 3
    v_xor_b32 v7, s56, v70
    v_lshl_add_u32 v61, v7, 5, v71
    s_add_u32 s56, s40, 2
    s_and_b32 s56, s56, 3
    v_xor_b32 v7, s56, v70
    v_lshl_add_u32 v62, v7, 5, v71
    s_add_u32 s56, s40, 3
    s_and_b32 s56, s56, 3
    v_xor_b32 v7, s56, v70
    v_lshl_add_u32 v63, v7, 5, v71
    v_mov_b32 v3, 162048
    v_mov_b32 v4, 1
    s_waitcnt lgkmcnt(0)
    s_mov_b64 exec, 1
    ds_add_u32 v3, v4
    s_mov_b64 exec, -1
    v_mov_b32 v3, 162072
    v_mov_b32 v4, 12
    s_mov_b64 exec, 1
    ds_add_u32 v3, v4
    s_mov_b64 exec, -1
    v_mov_b32 v3, 162080
    v_mov_b32 v4, 1
    s_waitcnt lgkmcnt(0)
    s_mov_b64 exec, 1
    ds_add_u32 v3, v4
    s_mov_b64 exec, -1
    v_mov_b32 v3, 162084
    v_mov_b32 v4, 1
    s_waitcnt lgkmcnt(0)
    s_mov_b64 exec, 1
    ds_add_u32 v3, v4
    s_mov_b64 exec, -1
    v_mov_b32 v3, 162100
    v_mov_b32 v4, 1
    s_waitcnt lgkmcnt(0)
    s_mov_b64 exec, 1
    ds_add_u32 v3, v4
    s_mov_b64 exec, -1
    s_waitcnt vmcnt(0)
    v_mov_b32 v3, 162052
    v_mov_b32 v4, 1
    s_waitcnt lgkmcnt(0)
    s_mov_b64 exec, 1
    ds_add_u32 v3, v4
    s_mov_b64 exec, -1
    v_mov_b32 v4, 162076
    s_mov_b32 s70, 0
LW_18:
    s_nop 4
    ds_read_b32 v5, v4
    s_add_u32 s70, s70, 1
    s_waitcnt lgkmcnt(0)
    v_readfirstlane_b32 s71, v5
    s_cmp_gt_u32 s70, 262144
    s_cbranch_scc1 LWX_19
    s_cmp_ge_u32 s71, 4
    s_cbranch_scc1 LWX_19
    s_sleep 1
    s_branch LW_18
LWX_19:
    s_nop 4
    v_lshrrev_b32 v3, 5, v2
    v_lshlrev_b32 v3, 12, v3
    v_and_b32 v4, 31, v2
    v_lshl_add_u32 v3, v4, 4, v3
    s_mul_i32 s57, s40, 1572864
    s_and_b32 s56, s65, 1
    s_lshl_b32 s56, s56, 17
    s_add_u32 s57, s57, s56
    s_lshl_b32 s56, s64, 9
    s_add_u32 s57, s57, s56
    s_mov_b32 s58, 0
KF_PF:
    s_nop 4
    buffer_load_dwordx4 v[72:75], v3, s[48:51], s57 offen
    s_add_u32 s57, s57, 8192
    s_waitcnt vmcnt(8)
    buffer_load_dwordx4 v[76:79], v3, s[48:51], s57 offen
    s_add_u32 s57, s57, 8192
    s_waitcnt vmcnt(8)
    buffer_load_dwordx4 v[80:83], v3, s[48:51], s57 offen
    s_add_u32 s57, s57, 8192
    s_waitcnt vmcnt(8)
    buffer_load_dwordx4 v[84:87], v3, s[48:51], s57 offen
    s_add_u32 s57, s57, 8192
    s_waitcnt vmcnt(8)
    buffer_load_dwordx4 v[88:91], v3, s[48:51], s57 offen
    s_add_u32 s57, s57, 8192
    s_waitcnt vmcnt(8)
    buffer_load_dwordx4 v[92:95], v3, s[48:51], s57 offen
    s_add_u32 s57, s57, 8192
    s_waitcnt vmcnt(8)
    buffer_load_dwordx4 v[96:99], v3, s[48:51], s57 offen
    s_add_u32 s57, s57, 8192
    s_waitcnt vmcnt(8)
    buffer_load_dwordx4 v[100:103], v3, s[48:51], s57 offen
    s_add_u32 s57, s57, 8192
    s_waitcnt vmcnt(8)
    buffer_load_dwordx4 v[104:107], v3, s[48:51], s57 offen
    s_add_u32 s57, s57, 8192
    s_waitcnt vmcnt(8)
    buffer_load_dwordx4 v[108:111], v3, s[48:51], s57 offen
    s_add_u32 s57, s57, 8192
    s_waitcnt vmcnt(8)
    buffer_load_dwordx4 v[112:115], v3, s[48:51], s57 offen
    s_add_u32 s57, s57, 8192
    s_waitcnt vmcnt(8)
    buffer_load_dwordx4 v[116:119], v3, s[48:51], s57 offen
    s_add_u32 s57, s57, 8192
    s_waitcnt vmcnt(8)
    buffer_load_dwordx4 v[120:123], v3, s[48:51], s57 offen
    s_add_u32 s57, s57, 8192
    s_waitcnt vmcnt(8)
    buffer_load_dwordx4 v[124:127], v3, s[48:51], s57 offen
    s_add_u32 s57, s57, 8192
    s_waitcnt vmcnt(8)
    buffer_load_dwordx4 v[128:131], v3, s[48:51], s57 offen
    s_add_u32 s57, s57, 8192
    s_waitcnt vmcnt(8)
    buffer_load_dwordx4 v[132:135], v3, s[48:51], s57 offen
    s_add_u32 s57, s57, 8192
    s_waitcnt vmcnt(8)
    s_add_u32 s57, s57, 131072
    s_add_u32 s58, s58, 1
    s_cmp_lt_u32 s58, 2
    s_cbranch_scc1 KF_PF
    s_lshl_b32 s47, s46, 17
    s_add_u32 s47, s47, s44
    s_add_u32 m0, s45, 12288
    s_add_u32 s46, s46, 1
    buffer_load_dwordx4 v56, s[48:51], s47 offen offset:0  lds
    buffer_load_dwordx4 v57, s[48:51], s47 offen offset:1024  lds
    buffer_load_dwordx4 v58, s[48:51], s47 offen offset:2048  lds
    buffer_load_dwordx4 v59, s[48:51], s47 offen offset:3072  lds
    s_lshl_b32 s47, s46, 17
    s_add_u32 s47, s47, s44
    s_add_u32 m0, s45, 16384
    s_add_u32 s46, s46, 1
    buffer_load_dwordx4 v56, s[48:51], s47 offen offset:0  lds
    buffer_load_dwordx4 v57, s[48:51], s47 offen offset:1024  lds
    buffer_load_dwordx4 v58, s[48:51], s47 offen offset:2048  lds
    buffer_load_dwordx4 v59, s[48:51], s47 offen offset:3072  lds
    s_lshl_b32 s47, s46, 17
    s_add_u32 s47, s47, s44
    s_add_u32 m0, s45, 20480
    s_add_u32 s46, s46, 1
    buffer_load_dwordx4 v56, s[48:51], s47 offen offset:0  lds
    buffer_load_dwordx4 v57, s[48:51], s47 offen offset:1024  lds
    buffer_load_dwordx4 v58, s[48:51], s47 offen offset:2048  lds
    buffer_load_dwordx4 v59, s[48:51], s47 offen offset:3072  lds
    s_waitcnt vmcnt(8)
    ds_read_b64_tr_b16 v[176:177], v60 offset:12288
    ds_read_b64_tr_b16 v[178:179], v60 offset:14336
    ds_read_b64_tr_b16 v[180:181], v61 offset:12288
    ds_read_b64_tr_b16 v[182:183], v61 offset:14336
    ds_read_b64_tr_b16 v[184:185], v62 offset:12288
    ds_read_b64_tr_b16 v[186:187], v62 offset:14336
    ds_read_b64_tr_b16 v[188:189], v63 offset:12288
    ds_read_b64_tr_b16 v[190:191], v63 offset:14336
    s_waitcnt vmcnt(4)
    ds_read_b64_tr_b16 v[192:193], v60 offset:16384
    ds_read_b64_tr_b16 v[194:195], v60 offset:18432
    ds_read_b64_tr_b16 v[196:197], v61 offset:16384
    ds_read_b64_tr_b16 v[198:199], v61 offset:18432
    ds_read_b64_tr_b16 v[200:201], v62 offset:16384
    ds_read_b64_tr_b16 v[202:203], v62 offset:18432
    ds_read_b64_tr_b16 v[204:205], v63 offset:16384
    ds_read_b64_tr_b16 v[206:207], v63 offset:18432
    s_waitcnt vmcnt(0)
    ds_read_b64_tr_b16 v[208:209], v60 offset:20480
    ds_read_b64_tr_b16 v[210:211], v60 offset:22528
    ds_read_b64_tr_b16 v[212:213], v61 offset:20480
    ds_read_b64_tr_b16 v[214:215], v61 offset:22528
    ds_read_b64_tr_b16 v[216:217], v62 offset:20480
    ds_read_b64_tr_b16 v[218:219], v62 offset:22528
    ds_read_b64_tr_b16 v[220:221], v63 offset:20480
    ds_read_b64_tr_b16 v[222:223], v63 offset:22528
    s_waitcnt lgkmcnt(0)
    s_lshl_b32 s47, s46, 17
    s_add_u32 s47, s47, s44
    s_add_u32 m0, s45, 12288
    s_add_u32 s46, s46, 1
    buffer_load_dwordx4 v56, s[48:51], s47 offen offset:0  lds
    buffer_load_dwordx4 v57, s[48:51], s47 offen offset:1024  lds
    buffer_load_dwordx4 v58, s[48:51], s47 offen offset:2048  lds
    buffer_load_dwordx4 v59, s[48:51], s47 offen offset:3072  lds
    s_lshl_b32 s47, s46, 17
    s_add_u32 s47, s47, s44
    s_add_u32 m0, s45, 16384
    s_add_u32 s46, s46, 1
    buffer_load_dwordx4 v56, s[48:51], s47 offen offset:0  lds
    buffer_load_dwordx4 v57, s[48:51], s47 offen offset:1024  lds
    buffer_load_dwordx4 v58, s[48:51], s47 offen offset:2048  lds
    buffer_load_dwordx4 v59, s[48:51], s47 offen offset:3072  lds
    s_lshl_b32 s47, s46, 17
    s_add_u32 s47, s47, s44
    s_add_u32 m0, s45, 20480
    s_add_u32 s46, s46, 1
    buffer_load_dwordx4 v56, s[48:51], s47 offen offset:0  lds
    buffer_load_dwordx4 v57, s[48:51], s47 offen offset:1024  lds
    buffer_load_dwordx4 v58, s[48:51], s47 offen offset:2048  lds
    buffer_load_dwordx4 v59, s[48:51], s47 offen offset:3072  lds
    s_waitcnt vmcnt(8)
    ds_read_b64_tr_b16 v[224:225], v60 offset:12288
    ds_read_b64_tr_b16 v[226:227], v60 offset:14336
    ds_read_b64_tr_b16 v[228:229], v61 offset:12288
    ds_read_b64_tr_b16 v[230:231], v61 offset:14336
    ds_read_b64_tr_b16 v[232:233], v62 offset:12288
    ds_read_b64_tr_b16 v[234:235], v62 offset:14336
    ds_read_b64_tr_b16 v[236:237], v63 offset:12288
    ds_read_b64_tr_b16 v[238:239], v63 offset:14336
    s_waitcnt vmcnt(4)
    ds_read_b64_tr_b16 v[240:241], v60 offset:16384
    ds_read_b64_tr_b16 v[242:243], v60 offset:18432
    ds_read_b64_tr_b16 v[244:245], v61 offset:16384
    ds_read_b64_tr_b16 v[246:247], v61 offset:18432
    ds_read_b64_tr_b16 v[248:249], v62 offset:16384
    ds_read_b64_tr_b16 v[250:251], v62 offset:18432
    ds_read_b64_tr_b16 v[252:253], v63 offset:16384
    ds_read_b64_tr_b16 v[254:255], v63 offset:18432
    s_waitcnt vmcnt(0) lgkmcnt(0)
KF_G2B:
    s_nop 4
    s_lshl_b32 s47, s46, 17
    s_add_u32 s47, s47, s44
    s_add_u32 m0, s45, 12288
    s_add_u32 s46, s46, 1
    buffer_load_dwordx4 v56, s[48:51], s47 offen offset:0  lds
    buffer_load_dwordx4 v57, s[48:51], s47 offen offset:1024  lds
    buffer_load_dwordx4 v58, s[48:51], s47 offen offset:2048  lds
    buffer_load_dwordx4 v59, s[48:51], s47 offen offset:3072  lds
    s_lshl_b32 s47, s46, 17
    s_add_u32 s47, s47, s44
    s_add_u32 m0, s45, 16384
    s_add_u32 s46, s46, 1
    buffer_load_dwordx4 v56, s[48:51], s47 offen offset:0  lds
    buffer_load_dwordx4 v57, s[48:51], s47 offen offset:1024  lds
    buffer_load_dwordx4 v58, s[48:51], s47 offen offset:2048  lds
    buffer_load_dwordx4 v59, s[48:51], s47 offen offset:3072  lds
    s_lshl_b32 s47, s46, 17
    s_add_u32 s47, s47, s44
    s_add_u32 m0, s45, 0
    s_add_u32 s46, s46, 1
    buffer_load_dwordx4 v56, s[48:51], s47 offen offset:0  lds
    buffer_load_dwordx4 v57, s[48:51], s47 offen offset:1024  lds
    buffer_load_dwordx4 v58, s[48:51], s47 offen offset:2048  lds
    buffer_load_dwordx4 v59, s[48:51], s47 offen offset:3072  lds
    s_lshl_b32 s47, s46, 17
    s_add_u32 s47, s47, s44
    s_add_u32 m0, s45, 4096
    s_add_u32 s46, s46, 1
    buffer_load_dwordx4 v56, s[48:51], s47 offen offset:0  lds
    buffer_load_dwordx4 v57, s[48:51], s47 offen offset:1024  lds
    buffer_load_dwordx4 v58, s[48:51], s47 offen offset:2048  lds
    buffer_load_dwordx4 v59, s[48:51], s47 offen offset:3072  lds
    s_mul_i32 s57, s62, 48
    s_mul_i32 s56, s40, 12
    s_add_u32 s57, s57, s56
    s_mul_i32 s57, s57, 5120
    s_add_u32 s57, s57, 8060928
    v_add_u32 v64, 4096, v68
    v_mul_u32_u24 v3, 43, v2
    v_lshrrev_b32 v3, 8, v3
    v_mul_u32_u24 v3, 18, v3
    v_add_u32 v3, v3, v2
    v_lshlrev_b32 v3, 6, v3
    s_mul_i32 s41, s62, 120
    s_mul_i32 s56, s40, 6
    s_add_u32 s41, s41, s56
    s_mul_i32 s41, s41, 64
    s_add_u32 s41, s41, 4096
    s_mov_b32 s42, -1
    s_mov_b32 s70, 0
FGP_21:
    s_nop 4
    s_and_b32 s56, s42, 0x30c30c3
    s_cbranch_scc0 FGOK_20
    s_add_u32 s70, s70, 1
    s_cmp_gt_u32 s70, 65536
    s_cbranch_scc1 FGOK_20
    s_mov_b32 exec_lo, 0x3fffffff
    s_mov_b32 exec_hi, 0x0
    buffer_load_dwordx2 v[4:5], v3, s[32:35], s41 offen sc1
    s_waitcnt vmcnt(0)
    v_cmp_ne_u64 vcc, s[30:31], v[4:5]
    s_mov_b64 exec, -1
    s_mov_b32 s42, vcc_lo
    s_branch FGP_21
FGOK_20:
    s_nop 4
    buffer_load_dwordx4 v[8:11], v68, s[32:35], s57 offen offset:0 sc1
    buffer_load_dwordx4 v[12:15], v68, s[32:35], s57 offen offset:1024 sc1
    buffer_load_dwordx4 v[16:19], v68, s[32:35], s57 offen offset:2048 sc1
    buffer_load_dwordx4 v[20:23], v68, s[32:35], s57 offen offset:3072 sc1
    buffer_load_dwordx4 v[24:27], v64, s[32:35], s57 offen sc1
    s_add_u32 s57, s57, 5120
    buffer_load_dwordx4 v[28:31], v68, s[32:35], s57 offen offset:0 sc1
    buffer_load_dwordx4 v[32:35], v68, s[32:35], s57 offen offset:1024 sc1
    buffer_load_dwordx4 v[36:39], v68, s[32:35], s57 offen offset:2048 sc1
    buffer_load_dwordx4 v[40:43], v68, s[32:35], s57 offen offset:3072 sc1
    buffer_load_dwordx4 v[44:47], v64, s[32:35], s57 offen sc1
    s_add_u32 s57, s57, 5120
    buffer_load_dwordx4 v[152:155], v68, s[32:35], s57 offen offset:0 sc1
    buffer_load_dwordx4 v[156:159], v68, s[32:35], s57 offen offset:1024 sc1
    buffer_load_dwordx4 v[160:163], v68, s[32:35], s57 offen offset:2048 sc1
    buffer_load_dwordx4 v[164:167], v68, s[32:35], s57 offen offset:3072 sc1
    buffer_load_dwordx4 v[168:171], v64, s[32:35], s57 offen sc1
    s_add_u32 s57, s57, 5120
    s_mov_b32 s52, s24
    s_and_b32 s53, s25, 0xffff
    s_mov_b32 s54, 4096
    s_mov_b32 s55, 0x00020000
    v_and_b32 v6, 15, v2
    v_lshrrev_b32 v7, 4, v2
    s_movk_i32 s56, 1280
    v_mul_u32_u24 v65, s56, v6
    v_lshl_add_u32 v65, v7, 3, v65
    v_lshlrev_b32 v66, 1, v6
    v_mul_u32_u24 v67, s56, v6
    v_and_b32 v6, 1, v7
    v_lshl_add_u32 v67, v6, 5, v67
    v_lshrrev_b32 v6, 1, v7
    v_lshl_add_u32 v67, v6, 4, v67
    s_lshl_b32 s60, s63, 6
    s_lshl_b32 s56, s40, 4
    s_add_u32 s60, s60, s56
    s_mul_i32 s61, s60, 1280
    s_mul_i32 s56, s62, 160
    s_add_u32 s61, s61, s56
    s_lshl_b32 s56, s60, 1
    buffer_load_ushort v174, v66, s[52:55], s56 offen
    v_mov_b32 v6, 162096
    v_mov_b32 v7, 1
    s_waitcnt vmcnt(11)
    v_mfma_f32_16x16x32_bf16 v[72:75], v[8:11], v[176:179], 0
    v_mfma_f32_16x16x32_bf16 v[76:79], v[8:11], v[180:183], 0
    v_mfma_f32_16x16x32_bf16 v[80:83], v[8:11], v[184:187], 0
    v_mfma_f32_16x16x32_bf16 v[84:87], v[8:11], v[188:191], 0
    buffer_load_dwordx4 v[8:11], v68, s[32:35], s57 offen offset:0 sc1
    v_mfma_f32_16x16x32_bf16 v[88:91], v[12:15], v[176:179], 0
    v_mfma_f32_16x16x32_bf16 v[92:95], v[12:15], v[180:183], 0
    v_mfma_f32_16x16x32_bf16 v[96:99], v[12:15], v[184:187], 0
    v_mfma_f32_16x16x32_bf16 v[100:103], v[12:15], v[188:191], 0
    buffer_load_dwordx4 v[12:15], v68, s[32:35], s57 offen offset:1024 sc1
    v_mfma_f32_16x16x32_bf16 v[104:107], v[16:19], v[176:179], 0
    v_mfma_f32_16x16x32_bf16 v[108:111], v[16:19], v[180:183], 0
    v_mfma_f32_16x16x32_bf16 v[112:115], v[16:19], v[184:187], 0
    v_mfma_f32_16x16x32_bf16 v[116:119], v[16:19], v[188:191], 0
    buffer_load_dwordx4 v[16:19], v68, s[32:35], s57 offen offset:2048 sc1
    v_mfma_f32_16x16x32_bf16 v[120:123], v[20:23], v[176:179], 0
    v_mfma_f32_16x16x32_bf16 v[124:127], v[20:23], v[180:183], 0
    v_mfma_f32_16x16x32_bf16 v[128:131], v[20:23], v[184:187], 0
    v_mfma_f32_16x16x32_bf16 v[132:135], v[20:23], v[188:191], 0
    buffer_load_dwordx4 v[20:23], v68, s[32:35], s57 offen offset:3072 sc1
    v_mfma_f32_16x16x32_bf16 v[136:139], v[24:27], v[176:179], 0
    v_mfma_f32_16x16x32_bf16 v[140:143], v[24:27], v[180:183], 0
    v_mfma_f32_16x16x32_bf16 v[144:147], v[24:27], v[184:187], 0
    v_mfma_f32_16x16x32_bf16 v[148:151], v[24:27], v[188:191], 0
    buffer_load_dwordx4 v[24:27], v64, s[32:35], s57 offen sc1
    s_add_u32 s57, s57, 5120
    s_mov_b32 s70, 0
FGP_23:
    s_nop 4
    s_and_b32 s56, s42, 0x4104104
    s_cbranch_scc0 FGOK_22
    s_add_u32 s70, s70, 1
    s_cmp_gt_u32 s70, 65536
    s_cbranch_scc1 FGOK_22
    s_mov_b32 exec_lo, 0x3fffffff
    s_mov_b32 exec_hi, 0x0
    buffer_load_dwordx2 v[4:5], v3, s[32:35], s41 offen sc1
    s_waitcnt vmcnt(0)
    v_cmp_ne_u64 vcc, s[30:31], v[4:5]
    s_mov_b64 exec, -1
    s_mov_b32 s42, vcc_lo
    s_branch FGP_23
FGOK_22:
    s_nop 4
    s_waitcnt vmcnt(11)
    v_mfma_f32_16x16x32_bf16 v[72:75], v[28:31], v[192:195], v[72:75]
    ds_read_b64_tr_b16 v[176:177], v60 offset:20480
    ds_read_b64_tr_b16 v[178:179], v60 offset:22528
    v_mfma_f32_16x16x32_bf16 v[76:79], v[28:31], v[196:199], v[76:79]
    ds_read_b64_tr_b16 v[180:181], v61 offset:20480
    ds_read_b64_tr_b16 v[182:183], v61 offset:22528
    v_mfma_f32_16x16x32_bf16 v[80:83], v[28:31], v[200:203], v[80:83]
    ds_read_b64_tr_b16 v[184:185], v62 offset:20480
    ds_read_b64_tr_b16 v[186:187], v62 offset:22528
    v_mfma_f32_16x16x32_bf16 v[84:87], v[28:31], v[204:207], v[84:87]
    buffer_load_dwordx4 v[28:31], v68, s[32:35], s57 offen offset:0 sc1
    v_mfma_f32_16x16x32_bf16 v[88:91], v[32:35], v[192:195], v[88:91]
    ds_read_b64_tr_b16 v[188:189], v63 offset:20480
    ds_read_b64_tr_b16 v[190:191], v63 offset:22528
    v_mfma_f32_16x16x32_bf16 v[92:95], v[32:35], v[196:199], v[92:95]
    v_mfma_f32_16x16x32_bf16 v[96:99], v[32:35], v[200:203], v[96:99]
    v_mfma_f32_16x16x32_bf16 v[100:103], v[32:35], v[204:207], v[100:103]
    buffer_load_dwordx4 v[32:35], v68, s[32:35], s57 offen offset:1024 sc1
    v_mfma_f32_16x16x32_bf16 v[104:107], v[36:39], v[192:195], v[104:107]
    v_mfma_f32_16x16x32_bf16 v[108:111], v[36:39], v[196:199], v[108:111]
    v_mfma_f32_16x16x32_bf16 v[112:115], v[36:39], v[200:203], v[112:115]
    v_mfma_f32_16x16x32_bf16 v[116:119], v[36:39], v[204:207], v[116:119]
    buffer_load_dwordx4 v[36:39], v68, s[32:35], s57 offen offset:2048 sc1
    v_mfma_f32_16x16x32_bf16 v[120:123], v[40:43], v[192:195], v[120:123]
    v_mfma_f32_16x16x32_bf16 v[124:127], v[40:43], v[196:199], v[124:127]
    v_mfma_f32_16x16x32_bf16 v[128:131], v[40:43], v[200:203], v[128:131]
    v_mfma_f32_16x16x32_bf16 v[132:135], v[40:43], v[204:207], v[132:135]
    buffer_load_dwordx4 v[40:43], v68, s[32:35], s57 offen offset:3072 sc1
    v_mfma_f32_16x16x32_bf16 v[136:139], v[44:47], v[192:195], v[136:139]
    v_mfma_f32_16x16x32_bf16 v[140:143], v[44:47], v[196:199], v[140:143]
    v_mfma_f32_16x16x32_bf16 v[144:147], v[44:47], v[200:203], v[144:147]
    v_mfma_f32_16x16x32_bf16 v[148:151], v[44:47], v[204:207], v[148:151]
    buffer_load_dwordx4 v[44:47], v64, s[32:35], s57 offen sc1
    s_add_u32 s57, s57, 5120
    s_waitcnt vmcnt(11)
    v_mfma_f32_16x16x32_bf16 v[72:75], v[152:155], v[208:211], v[72:75]
    s_waitcnt lgkmcnt(0)
    s_lshl_b32 s47, s46, 17
    s_add_u32 s47, s47, s44
    s_add_u32 m0, s45, 20480
    s_add_u32 s46, s46, 1
    v_mfma_f32_16x16x32_bf16 v[76:79], v[152:155], v[212:215], v[76:79]
    buffer_load_dwordx4 v56, s[48:51], s47 offen offset:0  lds
    v_mfma_f32_16x16x32_bf16 v[80:83], v[152:155], v[216:219], v[80:83]
    buffer_load_dwordx4 v57, s[48:51], s47 offen offset:1024  lds
    v_mfma_f32_16x16x32_bf16 v[84:87], v[152:155], v[220:223], v[84:87]
    buffer_load_dwordx4 v[152:155], v68, s[32:35], s57 offen offset:0 sc1
    v_mfma_f32_16x16x32_bf16 v[88:91], v[156:159], v[208:211], v[88:91]
    buffer_load_dwordx4 v58, s[48:51], s47 offen offset:2048  lds
    v_mfma_f32_16x16x32_bf16 v[92:95], v[156:159], v[212:215], v[92:95]
    buffer_load_dwordx4 v59, s[48:51], s47 offen offset:3072  lds
    v_mfma_f32_16x16x32_bf16 v[96:99], v[156:159], v[216:219], v[96:99]
    ds_read_b64_tr_b16 v[192:193], v60 offset:12288
    ds_read_b64_tr_b16 v[194:195], v60 offset:14336
    v_mfma_f32_16x16x32_bf16 v[100:103], v[156:159], v[220:223], v[100:103]
    buffer_load_dwordx4 v[156:159], v68, s[32:35], s57 offen offset:1024 sc1
    v_mfma_f32_16x16x32_bf16 v[104:107], v[160:163], v[208:211], v[104:107]
    ds_read_b64_tr_b16 v[196:197], v61 offset:12288
    ds_read_b64_tr_b16 v[198:199], v61 offset:14336
    v_mfma_f32_16x16x32_bf16 v[108:111], v[160:163], v[212:215], v[108:111]
    ds_read_b64_tr_b16 v[200:201], v62 offset:12288
    ds_read_b64_tr_b16 v[202:203], v62 offset:14336
    v_mfma_f32_16x16x32_bf16 v[112:115], v[160:163], v[216:219], v[112:115]
    ds_read_b64_tr_b16 v[204:205], v63 offset:12288
    ds_read_b64_tr_b16 v[206:207], v63 offset:14336
    v_mfma_f32_16x16x32_bf16 v[116:119], v[160:163], v[220:223], v[116:119]
    buffer_load_dwordx4 v[160:163], v68, s[32:35], s57 offen offset:2048 sc1
    v_mfma_f32_16x16x32_bf16 v[120:123], v[164:167], v[208:211], v[120:123]
    s_mov_b64 exec, 1
    ds_add_u32 v6, v7
    s_mov_b64 exec, -1
    v_mfma_f32_16x16x32_bf16 v[124:127], v[164:167], v[212:215], v[124:127]
    v_mfma_f32_16x16x32_bf16 v[128:131], v[164:167], v[216:219], v[128:131]
    v_mfma_f32_16x16x32_bf16 v[132:135], v[164:167], v[220:223], v[132:135]
    buffer_load_dwordx4 v[164:167], v68, s[32:35], s57 offen offset:3072 sc1
    v_mfma_f32_16x16x32_bf16 v[136:139], v[168:171], v[208:211], v[136:139]
    v_mfma_f32_16x16x32_bf16 v[140:143], v[168:171], v[212:215], v[140:143]
    v_mfma_f32_16x16x32_bf16 v[144:147], v[168:171], v[216:219], v[144:147]
    v_mfma_f32_16x16x32_bf16 v[148:151], v[168:171], v[220:223], v[148:151]
    buffer_load_dwordx4 v[168:171], v64, s[32:35], s57 offen sc1
    s_add_u32 s57, s57, 5120
    s_mov_b32 s70, 0
FGP_25:
    s_nop 4
    s_and_b32 s56, s42, 0x8208208
    s_cbranch_scc0 FGOK_24
    s_add_u32 s70, s70, 1
    s_cmp_gt_u32 s70, 65536
    s_cbranch_scc1 FGOK_24
    s_mov_b32 exec_lo, 0x3fffffff
    s_mov_b32 exec_hi, 0x0
    buffer_load_dwordx2 v[4:5], v3, s[32:35], s41 offen sc1
    s_waitcnt vmcnt(0)
    v_cmp_ne_u64 vcc, s[30:31], v[4:5]
    s_mov_b64 exec, -1
    s_mov_b32 s42, vcc_lo
    s_branch FGP_25
FGOK_24:
    s_nop 4
    s_waitcnt vmcnt(14)
    v_mfma_f32_16x16x32_bf16 v[72:75], v[8:11], v[224:227], v[72:75]
    s_waitcnt lgkmcnt(1)
    s_lshl_b32 s47, s46, 17
    s_add_u32 s47, s47, s44
    s_add_u32 m0, s45, 12288
    s_add_u32 s46, s46, 1
    v_mfma_f32_16x16x32_bf16 v[76:79], v[8:11], v[228:231], v[76:79]
    buffer_load_dwordx4 v56, s[48:51], s47 offen offset:0  lds
    v_mfma_f32_16x16x32_bf16 v[80:83], v[8:11], v[232:235], v[80:83]
    buffer_load_dwordx4 v57, s[48:51], s47 offen offset:1024  lds
    v_mfma_f32_16x16x32_bf16 v[84:87], v[8:11], v[236:239], v[84:87]
    buffer_load_dwordx4 v[8:11], v68, s[32:35], s57 offen offset:0 sc1
    v_mfma_f32_16x16x32_bf16 v[88:91], v[12:15], v[224:227], v[88:91]
    buffer_load_dwordx4 v58, s[48:51], s47 offen offset:2048  lds
    v_mfma_f32_16x16x32_bf16 v[92:95], v[12:15], v[228:231], v[92:95]
    buffer_load_dwordx4 v59, s[48:51], s47 offen offset:3072  lds
    v_mfma_f32_16x16x32_bf16 v[96:99], v[12:15], v[232:235], v[96:99]
    ds_read_b64_tr_b16 v[208:209], v60 offset:16384
    ds_read_b64_tr_b16 v[210:211], v60 offset:18432
    v_mfma_f32_16x16x32_bf16 v[100:103], v[12:15], v[236:239], v[100:103]
    buffer_load_dwordx4 v[12:15], v68, s[32:35], s57 offen offset:1024 sc1
    v_mfma_f32_16x16x32_bf16 v[104:107], v[16:19], v[224:227], v[104:107]
    ds_read_b64_tr_b16 v[212:213], v61 offset:16384
    ds_read_b64_tr_b16 v[214:215], v61 offset:18432
    v_mfma_f32_16x16x32_bf16 v[108:111], v[16:19], v[228:231], v[108:111]
    ds_read_b64_tr_b16 v[216:217], v62 offset:16384
    ds_read_b64_tr_b16 v[218:219], v62 offset:18432
    v_mfma_f32_16x16x32_bf16 v[112:115], v[16:19], v[232:235], v[112:115]
    ds_read_b64_tr_b16 v[220:221], v63 offset:16384
    ds_read_b64_tr_b16 v[222:223], v63 offset:18432
    v_mfma_f32_16x16x32_bf16 v[116:119], v[16:19], v[236:239], v[116:119]
    buffer_load_dwordx4 v[16:19], v68, s[32:35], s57 offen offset:2048 sc1
    v_mfma_f32_16x16x32_bf16 v[120:123], v[20:23], v[224:227], v[120:123]
    v_mfma_f32_16x16x32_bf16 v[124:127], v[20:23], v[228:231], v[124:127]
    v_mfma_f32_16x16x32_bf16 v[128:131], v[20:23], v[232:235], v[128:131]
    v_mfma_f32_16x16x32_bf16 v[132:135], v[20:23], v[236:239], v[132:135]
    buffer_load_dwordx4 v[20:23], v68, s[32:35], s57 offen offset:3072 sc1
    v_mfma_f32_16x16x32_bf16 v[136:139], v[24:27], v[224:227], v[136:139]
    v_mfma_f32_16x16x32_bf16 v[140:143], v[24:27], v[228:231], v[140:143]
    v_mfma_f32_16x16x32_bf16 v[144:147], v[24:27], v[232:235], v[144:147]
    v_mfma_f32_16x16x32_bf16 v[148:151], v[24:27], v[236:239], v[148:151]
    buffer_load_dwordx4 v[24:27], v64, s[32:35], s57 offen sc1
    s_add_u32 s57, s57, 5120
    s_waitcnt vmcnt(18)
    v_mfma_f32_16x16x32_bf16 v[72:75], v[28:31], v[240:243], v[72:75]
    ds_read_b64_tr_b16 v[224:225], v60 offset:0
    ds_read_b64_tr_b16 v[226:227], v60 offset:2048
    v_mfma_f32_16x16x32_bf16 v[76:79], v[28:31], v[244:247], v[76:79]
    ds_read_b64_tr_b16 v[228:229], v61 offset:0
    ds_read_b64_tr_b16 v[230:231], v61 offset:2048
    v_mfma_f32_16x16x32_bf16 v[80:83], v[28:31], v[248:251], v[80:83]
    ds_read_b64_tr_b16 v[232:233], v62 offset:0
    ds_read_b64_tr_b16 v[234:235], v62 offset:2048
    v_mfma_f32_16x16x32_bf16 v[84:87], v[28:31], v[252:255], v[84:87]
    buffer_load_dwordx4 v[28:31], v68, s[32:35], s57 offen offset:0 sc1
    v_mfma_f32_16x16x32_bf16 v[88:91], v[32:35], v[240:243], v[88:91]
    ds_read_b64_tr_b16 v[236:237], v63 offset:0
    ds_read_b64_tr_b16 v[238:239], v63 offset:2048
    v_mfma_f32_16x16x32_bf16 v[92:95], v[32:35], v[244:247], v[92:95]
    v_mfma_f32_16x16x32_bf16 v[96:99], v[32:35], v[248:251], v[96:99]
    v_mfma_f32_16x16x32_bf16 v[100:103], v[32:35], v[252:255], v[100:103]
    buffer_load_dwordx4 v[32:35], v68, s[32:35], s57 offen offset:1024 sc1
    v_mfma_f32_16x16x32_bf16 v[104:107], v[36:39], v[240:243], v[104:107]
    v_mfma_f32_16x16x32_bf16 v[108:111], v[36:39], v[244:247], v[108:111]
    v_mfma_f32_16x16x32_bf16 v[112:115], v[36:39], v[248:251], v[112:115]
    v_mfma_f32_16x16x32_bf16 v[116:119], v[36:39], v[252:255], v[116:119]
    buffer_load_dwordx4 v[36:39], v68, s[32:35], s57 offen offset:2048 sc1
    v_mfma_f32_16x16x32_bf16 v[120:123], v[40:43], v[240:243], v[120:123]
    v_mfma_f32_16x16x32_bf16 v[124:127], v[40:43], v[244:247], v[124:127]
    v_mfma_f32_16x16x32_bf16 v[128:131], v[40:43], v[248:251], v[128:131]
    v_mfma_f32_16x16x32_bf16 v[132:135], v[40:43], v[252:255], v[132:135]
    buffer_load_dwordx4 v[40:43], v68, s[32:35], s57 offen offset:3072 sc1
    v_mfma_f32_16x16x32_bf16 v[136:139], v[44:47], v[240:243], v[136:139]
    v_mfma_f32_16x16x32_bf16 v[140:143], v[44:47], v[244:247], v[140:143]
    v_mfma_f32_16x16x32_bf16 v[144:147], v[44:47], v[248:251], v[144:147]
    v_mfma_f32_16x16x32_bf16 v[148:151], v[44:47], v[252:255], v[148:151]
    buffer_load_dwordx4 v[44:47], v64, s[32:35], s57 offen sc1
    s_add_u32 s57, s57, 5120
    s_mov_b32 s70, 0
FGP_27:
    s_nop 4
    s_and_b32 s56, s42, 0x10410410
    s_cbranch_scc0 FGOK_26
    s_add_u32 s70, s70, 1
    s_cmp_gt_u32 s70, 65536
    s_cbranch_scc1 FGOK_26
    s_mov_b32 exec_lo, 0x3fffffff
    s_mov_b32 exec_hi, 0x0
    buffer_load_dwordx2 v[4:5], v3, s[32:35], s41 offen sc1
    s_waitcnt vmcnt(0)
    v_cmp_ne_u64 vcc, s[30:31], v[4:5]
    s_mov_b64 exec, -1
    s_mov_b32 s42, vcc_lo
    s_branch FGP_27
FGOK_26:
    s_nop 4
    s_waitcnt vmcnt(14)
    v_mfma_f32_16x16x32_bf16 v[72:75], v[152:155], v[176:179], v[72:75]
    ds_read_b64_tr_b16 v[240:241], v60 offset:4096
    ds_read_b64_tr_b16 v[242:243], v60 offset:6144
    v_mfma_f32_16x16x32_bf16 v[76:79], v[152:155], v[180:183], v[76:79]
    ds_read_b64_tr_b16 v[244:245], v61 offset:4096
    ds_read_b64_tr_b16 v[246:247], v61 offset:6144
    v_mfma_f32_16x16x32_bf16 v[80:83], v[152:155], v[184:187], v[80:83]
    ds_read_b64_tr_b16 v[248:249], v62 offset:4096
    ds_read_b64_tr_b16 v[250:251], v62 offset:6144
    v_mfma_f32_16x16x32_bf16 v[84:87], v[152:155], v[188:191], v[84:87]
    buffer_load_dwordx4 v[152:155], v68, s[32:35], s57 offen offset:0 sc1
    v_mfma_f32_16x16x32_bf16 v[88:91], v[156:159], v[176:179], v[88:91]
    ds_read_b64_tr_b16 v[252:253], v63 offset:4096
    ds_read_b64_tr_b16 v[254:255], v63 offset:6144
    v_mfma_f32_16x16x32_bf16 v[92:95], v[156:159], v[180:183], v[92:95]
    v_mfma_f32_16x16x32_bf16 v[96:99], v[156:159], v[184:187], v[96:99]
    v_mfma_f32_16x16x32_bf16 v[100:103], v[156:159], v[188:191], v[100:103]
    buffer_load_dwordx4 v[156:159], v68, s[32:35], s57 offen offset:1024 sc1
    v_mfma_f32_16x16x32_bf16 v[104:107], v[160:163], v[176:179], v[104:107]
    v_mfma_f32_16x16x32_bf16 v[108:111], v[160:163], v[180:183], v[108:111]
    v_mfma_f32_16x16x32_bf16 v[112:115], v[160:163], v[184:187], v[112:115]
    v_mfma_f32_16x16x32_bf16 v[116:119], v[160:163], v[188:191], v[116:119]
    buffer_load_dwordx4 v[160:163], v68, s[32:35], s57 offen offset:2048 sc1
    v_mfma_f32_16x16x32_bf16 v[120:123], v[164:167], v[176:179], v[120:123]
    v_mfma_f32_16x16x32_bf16 v[124:127], v[164:167], v[180:183], v[124:127]
    v_mfma_f32_16x16x32_bf16 v[128:131], v[164:167], v[184:187], v[128:131]
    v_mfma_f32_16x16x32_bf16 v[132:135], v[164:167], v[188:191], v[132:135]
    buffer_load_dwordx4 v[164:167], v68, s[32:35], s57 offen offset:3072 sc1
    v_mfma_f32_16x16x32_bf16 v[136:139], v[168:171], v[176:179], v[136:139]
    v_mfma_f32_16x16x32_bf16 v[140:143], v[168:171], v[180:183], v[140:143]
    v_mfma_f32_16x16x32_bf16 v[144:147], v[168:171], v[184:187], v[144:147]
    v_mfma_f32_16x16x32_bf16 v[148:151], v[168:171], v[188:191], v[148:151]
    buffer_load_dwordx4 v[168:171], v64, s[32:35], s57 offen sc1
    s_add_u32 s57, s57, 5120
    s_waitcnt vmcnt(10)
    v_mfma_f32_16x16x32_bf16 v[72:75], v[8:11], v[192:195], v[72:75]
    ds_read_b64_tr_b16 v[176:177], v60 offset:20480
    ds_read_b64_tr_b16 v[178:179], v60 offset:22528
    v_mfma_f32_16x16x32_bf16 v[76:79], v[8:11], v[196:199], v[76:79]
    ds_read_b64_tr_b16 v[180:181], v61 offset:20480
    ds_read_b64_tr_b16 v[182:183], v61 offset:22528
    v_mfma_f32_16x16x32_bf16 v[80:83], v[8:11], v[200:203], v[80:83]
    ds_read_b64_tr_b16 v[184:185], v62 offset:20480
    ds_read_b64_tr_b16 v[186:187], v62 offset:22528
    v_mfma_f32_16x16x32_bf16 v[84:87], v[8:11], v[204:207], v[84:87]
    buffer_load_dwordx4 v[8:11], v68, s[32:35], s57 offen offset:0 sc1
    v_mfma_f32_16x16x32_bf16 v[88:91], v[12:15], v[192:195], v[88:91]
    ds_read_b64_tr_b16 v[188:189], v63 offset:20480
    ds_read_b64_tr_b16 v[190:191], v63 offset:22528
    v_mfma_f32_16x16x32_bf16 v[92:95], v[12:15], v[196:199], v[92:95]
    v_mfma_f32_16x16x32_bf16 v[96:99], v[12:15], v[200:203], v[96:99]
    v_mfma_f32_16x16x32_bf16 v[100:103], v[12:15], v[204:207], v[100:103]
    buffer_load_dwordx4 v[12:15], v68, s[32:35], s57 offen offset:1024 sc1
    v_mfma_f32_16x16x32_bf16 v[104:107], v[16:19], v[192:195], v[104:107]
    v_mfma_f32_16x16x32_bf16 v[108:111], v[16:19], v[196:199], v[108:111]
    v_mfma_f32_16x16x32_bf16 v[112:115], v[16:19], v[200:203], v[112:115]
    v_mfma_f32_16x16x32_bf16 v[116:119], v[16:19], v[204:207], v[116:119]
    buffer_load_dwordx4 v[16:19], v68, s[32:35], s57 offen offset:2048 sc1
    v_mfma_f32_16x16x32_bf16 v[120:123], v[20:23], v[192:195], v[120:123]
    v_mfma_f32_16x16x32_bf16 v[124:127], v[20:23], v[196:199], v[124:127]
    v_mfma_f32_16x16x32_bf16 v[128:131], v[20:23], v[200:203], v[128:131]
    v_mfma_f32_16x16x32_bf16 v[132:135], v[20:23], v[204:207], v[132:135]
    buffer_load_dwordx4 v[20:23], v68, s[32:35], s57 offen offset:3072 sc1
    v_mfma_f32_16x16x32_bf16 v[136:139], v[24:27], v[192:195], v[136:139]
    v_mfma_f32_16x16x32_bf16 v[140:143], v[24:27], v[196:199], v[140:143]
    v_mfma_f32_16x16x32_bf16 v[144:147], v[24:27], v[200:203], v[144:147]
    v_mfma_f32_16x16x32_bf16 v[148:151], v[24:27], v[204:207], v[148:151]
    buffer_load_dwordx4 v[24:27], v64, s[32:35], s57 offen sc1
    s_add_u32 s57, s57, 5120
    s_mov_b32 s70, 0
FGP_29:
    s_nop 4
    s_and_b32 s56, s42, 0x20820820
    s_cbranch_scc0 FGOK_28
    s_add_u32 s70, s70, 1
    s_cmp_gt_u32 s70, 65536
    s_cbranch_scc1 FGOK_28
    s_mov_b32 exec_lo, 0x3fffffff
    s_mov_b32 exec_hi, 0x0
    buffer_load_dwordx2 v[4:5], v3, s[32:35], s41 offen sc1
    s_waitcnt vmcnt(0)
    v_cmp_ne_u64 vcc, s[30:31], v[4:5]
    s_mov_b64 exec, -1
    s_mov_b32 s42, vcc_lo
    s_branch FGP_29
FGOK_28:
    s_nop 4
    s_waitcnt vmcnt(10) lgkmcnt(15)
    v_mfma_f32_16x16x32_bf16 v[72:75], v[28:31], v[208:211], v[72:75]
    ds_read_b64_tr_b16 v[192:193], v60 offset:12288
    ds_read_b64_tr_b16 v[194:195], v60 offset:14336
    v_mfma_f32_16x16x32_bf16 v[76:79], v[28:31], v[212:215], v[76:79]
    ds_read_b64_tr_b16 v[196:197], v61 offset:12288
    ds_read_b64_tr_b16 v[198:199], v61 offset:14336
    v_mfma_f32_16x16x32_bf16 v[80:83], v[28:31], v[216:219], v[80:83]
    ds_read_b64_tr_b16 v[200:201], v62 offset:12288
    ds_read_b64_tr_b16 v[202:203], v62 offset:14336
    v_mfma_f32_16x16x32_bf16 v[84:87], v[28:31], v[220:223], v[84:87]
    buffer_load_dwordx4 v[28:31], v68, s[32:35], s57 offen offset:0 sc1
    v_mfma_f32_16x16x32_bf16 v[88:91], v[32:35], v[208:211], v[88:91]
    ds_read_b64_tr_b16 v[204:205], v63 offset:12288
    ds_read_b64_tr_b16 v[206:207], v63 offset:14336
    v_mfma_f32_16x16x32_bf16 v[92:95], v[32:35], v[212:215], v[92:95]
    v_mfma_f32_16x16x32_bf16 v[96:99], v[32:35], v[216:219], v[96:99]
    v_mfma_f32_16x16x32_bf16 v[100:103], v[32:35], v[220:223], v[100:103]
    buffer_load_dwordx4 v[32:35], v68, s[32:35], s57 offen offset:1024 sc1
    v_mfma_f32_16x16x32_bf16 v[104:107], v[36:39], v[208:211], v[104:107]
    v_mfma_f32_16x16x32_bf16 v[108:111], v[36:39], v[212:215], v[108:111]
    v_mfma_f32_16x16x32_bf16 v[112:115], v[36:39], v[216:219], v[112:115]
    v_mfma_f32_16x16x32_bf16 v[116:119], v[36:39], v[220:223], v[116:119]
    buffer_load_dwordx4 v[36:39], v68, s[32:35], s57 offen offset:2048 sc1
    v_mfma_f32_16x16x32_bf16 v[120:123], v[40:43], v[208:211], v[120:123]
    v_mfma_f32_16x16x32_bf16 v[124:127], v[40:43], v[212:215], v[124:127]
    v_mfma_f32_16x16x32_bf16 v[128:131], v[40:43], v[216:219], v[128:131]
    v_mfma_f32_16x16x32_bf16 v[132:135], v[40:43], v[220:223], v[132:135]
    buffer_load_dwordx4 v[40:43], v68, s[32:35], s57 offen offset:3072 sc1
    v_mfma_f32_16x16x32_bf16 v[136:139], v[44:47], v[208:211], v[136:139]
    v_mfma_f32_16x16x32_bf16 v[140:143], v[44:47], v[212:215], v[140:143]
    v_mfma_f32_16x16x32_bf16 v[144:147], v[44:47], v[216:219], v[144:147]
    v_mfma_f32_16x16x32_bf16 v[148:151], v[44:47], v[220:223], v[148:151]
    buffer_load_dwordx4 v[44:47], v64, s[32:35], s57 offen sc1
    s_add_u32 s57, s57, 5120
    s_waitcnt vmcnt(10)
    v_mfma_f32_16x16x32_bf16 v[72:75], v[152:155], v[224:227], v[72:75]
    v_mfma_f32_16x16x32_bf16 v[76:79], v[152:155], v[228:231], v[76:79]
    v_mfma_f32_16x16x32_bf16 v[80:83], v[152:155], v[232:235], v[80:83]
    v_mfma_f32_16x16x32_bf16 v[84:87], v[152:155], v[236:239], v[84:87]
    buffer_load_dwordx4 v[152:155], v68, s[32:35], s57 offen offset:0 sc1
    v_mfma_f32_16x16x32_bf16 v[88:91], v[156:159], v[224:227], v[88:91]
    v_mfma_f32_16x16x32_bf16 v[92:95], v[156:159], v[228:231], v[92:95]
    v_mfma_f32_16x16x32_bf16 v[96:99], v[156:159], v[232:235], v[96:99]
    v_mfma_f32_16x16x32_bf16 v[100:103], v[156:159], v[236:239], v[100:103]
    buffer_load_dwordx4 v[156:159], v68, s[32:35], s57 offen offset:1024 sc1
    v_mfma_f32_16x16x32_bf16 v[104:107], v[160:163], v[224:227], v[104:107]
    v_mfma_f32_16x16x32_bf16 v[108:111], v[160:163], v[228:231], v[108:111]
    v_mfma_f32_16x16x32_bf16 v[112:115], v[160:163], v[232:235], v[112:115]
    v_mfma_f32_16x16x32_bf16 v[116:119], v[160:163], v[236:239], v[116:119]
    buffer_load_dwordx4 v[160:163], v68, s[32:35], s57 offen offset:2048 sc1
    v_mfma_f32_16x16x32_bf16 v[120:123], v[164:167], v[224:227], v[120:123]
    v_mfma_f32_16x16x32_bf16 v[124:127], v[164:167], v[228:231], v[124:127]
    v_mfma_f32_16x16x32_bf16 v[128:131], v[164:167], v[232:235], v[128:131]
    v_mfma_f32_16x16x32_bf16 v[132:135], v[164:167], v[236:239], v[132:135]
    buffer_load_dwordx4 v[164:167], v68, s[32:35], s57 offen offset:3072 sc1
    v_mfma_f32_16x16x32_bf16 v[136:139], v[168:171], v[224:227], v[136:139]
    v_mfma_f32_16x16x32_bf16 v[140:143], v[168:171], v[228:231], v[140:143]
    v_mfma_f32_16x16x32_bf16 v[144:147], v[168:171], v[232:235], v[144:147]
    v_mfma_f32_16x16x32_bf16 v[148:151], v[168:171], v[236:239], v[148:151]
    buffer_load_dwordx4 v[168:171], v64, s[32:35], s57 offen sc1
    s_add_u32 s57, s57, 5120
    s_waitcnt vmcnt(10) lgkmcnt(15)
    v_mfma_f32_16x16x32_bf16 v[72:75], v[8:11], v[240:243], v[72:75]
    v_mfma_f32_16x16x32_bf16 v[76:79], v[8:11], v[244:247], v[76:79]
    v_mfma_f32_16x16x32_bf16 v[80:83], v[8:11], v[248:251], v[80:83]
    v_mfma_f32_16x16x32_bf16 v[84:87], v[8:11], v[252:255], v[84:87]
    v_mfma_f32_16x16x32_bf16 v[88:91], v[12:15], v[240:243], v[88:91]
    v_mfma_f32_16x16x32_bf16 v[92:95], v[12:15], v[244:247], v[92:95]
    v_mfma_f32_16x16x32_bf16 v[96:99], v[12:15], v[248:251], v[96:99]
    v_mfma_f32_16x16x32_bf16 v[100:103], v[12:15], v[252:255], v[100:103]
    v_mfma_f32_16x16x32_bf16 v[104:107], v[16:19], v[240:243], v[104:107]
    v_mfma_f32_16x16x32_bf16 v[108:111], v[16:19], v[244:247], v[108:111]
    v_mfma_f32_16x16x32_bf16 v[112:115], v[16:19], v[248:251], v[112:115]
    v_mfma_f32_16x16x32_bf16 v[116:119], v[16:19], v[252:255], v[116:119]
    v_mfma_f32_16x16x32_bf16 v[120:123], v[20:23], v[240:243], v[120:123]
    v_mfma_f32_16x16x32_bf16 v[124:127], v[20:23], v[244:247], v[124:127]
    v_mfma_f32_16x16x32_bf16 v[128:131], v[20:23], v[248:251], v[128:131]
    v_mfma_f32_16x16x32_bf16 v[132:135], v[20:23], v[252:255], v[132:135]
    v_mfma_f32_16x16x32_bf16 v[136:139], v[24:27], v[240:243], v[136:139]
    v_mfma_f32_16x16x32_bf16 v[140:143], v[24:27], v[244:247], v[140:143]
    v_mfma_f32_16x16x32_bf16 v[144:147], v[24:27], v[248:251], v[144:147]
    v_mfma_f32_16x16x32_bf16 v[148:151], v[24:27], v[252:255], v[148:151]
    s_waitcnt vmcnt(5) lgkmcnt(8)
    v_mfma_f32_16x16x32_bf16 v[72:75], v[28:31], v[176:179], v[72:75]
    v_mfma_f32_16x16x32_bf16 v[76:79], v[28:31], v[180:183], v[76:79]
    v_mfma_f32_16x16x32_bf16 v[80:83], v[28:31], v[184:187], v[80:83]
    v_mfma_f32_16x16x32_bf16 v[84:87], v[28:31], v[188:191], v[84:87]
    v_mfma_f32_16x16x32_bf16 v[88:91], v[32:35], v[176:179], v[88:91]
    v_mfma_f32_16x16x32_bf16 v[92:95], v[32:35], v[180:183], v[92:95]
    v_mfma_f32_16x16x32_bf16 v[96:99], v[32:35], v[184:187], v[96:99]
    v_mfma_f32_16x16x32_bf16 v[100:103], v[32:35], v[188:191], v[100:103]
    v_mfma_f32_16x16x32_bf16 v[104:107], v[36:39], v[176:179], v[104:107]
    v_mfma_f32_16x16x32_bf16 v[108:111], v[36:39], v[180:183], v[108:111]
    v_mfma_f32_16x16x32_bf16 v[112:115], v[36:39], v[184:187], v[112:115]
    v_mfma_f32_16x16x32_bf16 v[116:119], v[36:39], v[188:191], v[116:119]
    v_mfma_f32_16x16x32_bf16 v[120:123], v[40:43], v[176:179], v[120:123]
    v_mfma_f32_16x16x32_bf16 v[124:127], v[40:43], v[180:183], v[124:127]
    v_mfma_f32_16x16x32_bf16 v[128:131], v[40:43], v[184:187], v[128:131]
    v_mfma_f32_16x16x32_bf16 v[132:135], v[40:43], v[188:191], v[132:135]
    v_mfma_f32_16x16x32_bf16 v[136:139], v[44:47], v[176:179], v[136:139]
    v_mfma_f32_16x16x32_bf16 v[140:143], v[44:47], v[180:183], v[140:143]
    v_mfma_f32_16x16x32_bf16 v[144:147], v[44:47], v[184:187], v[144:147]
    v_mfma_f32_16x16x32_bf16 v[148:151], v[44:47], v[188:191], v[148:151]
    s_waitcnt vmcnt(0) lgkmcnt(0)
    v_add_u32 v4, s45, v68
    v_mfma_f32_16x16x32_bf16 v[72:75], v[152:155], v[192:195], v[72:75]
    v_mfma_f32_16x16x32_bf16 v[76:79], v[152:155], v[196:199], v[76:79]
    v_mfma_f32_16x16x32_bf16 v[80:83], v[152:155], v[200:203], v[80:83]
    v_mfma_f32_16x16x32_bf16 v[84:87], v[152:155], v[204:207], v[84:87]
    v_mfma_f32_16x16x32_bf16 v[88:91], v[156:159], v[192:195], v[88:91]
    v_mfma_f32_16x16x32_bf16 v[92:95], v[156:159], v[196:199], v[92:95]
    v_mfma_f32_16x16x32_bf16 v[96:99], v[156:159], v[200:203], v[96:99]
    v_mfma_f32_16x16x32_bf16 v[100:103], v[156:159], v[204:207], v[100:103]
    v_mfma_f32_16x16x32_bf16 v[104:107], v[160:163], v[192:195], v[104:107]
    v_mfma_f32_16x16x32_bf16 v[108:111], v[160:163], v[196:199], v[108:111]
    ds_write_b128 v4, v[76:79] offset:0
    v_mfma_f32_16x16x32_bf16 v[112:115], v[160:163], v[200:203], v[112:115]
    ds_write_b128 v4, v[80:83] offset:5120
    v_mfma_f32_16x16x32_bf16 v[116:119], v[160:163], v[204:207], v[116:119]
    ds_write_b128 v4, v[84:87] offset:14336
    v_mfma_f32_16x16x32_bf16 v[120:123], v[164:167], v[192:195], v[120:123]
    v_mfma_f32_16x16x32_bf16 v[124:127], v[164:167], v[196:199], v[124:127]
    ds_write_b128 v4, v[92:95] offset:1024
    v_mfma_f32_16x16x32_bf16 v[128:131], v[164:167], v[200:203], v[128:131]
    ds_write_b128 v4, v[96:99] offset:6144
    v_mfma_f32_16x16x32_bf16 v[132:135], v[164:167], v[204:207], v[132:135]
    ds_write_b128 v4, v[100:103] offset:15360
    v_mfma_f32_16x16x32_bf16 v[136:139], v[168:171], v[192:195], v[136:139]
    v_mfma_f32_16x16x32_bf16 v[140:143], v[168:171], v[196:199], v[140:143]
    ds_write_b128 v4, v[108:111] offset:2048
    v_mfma_f32_16x16x32_bf16 v[144:147], v[168:171], v[200:203], v[144:147]
    ds_write_b128 v4, v[112:115] offset:7168
    v_mfma_f32_16x16x32_bf16 v[148:151], v[168:171], v[204:207], v[148:151]
    ds_write_b128 v4, v[116:119] offset:16384
    ds_write_b128 v4, v[124:127] offset:3072
    ds_write_b128 v4, v[128:131] offset:12288
    ds_write_b128 v4, v[132:135] offset:17408
    ds_write_b128 v4, v[140:143] offset:4096
    s_nop 0
    ds_write_b128 v4, v[144:147] offset:13312
    s_nop 0
    ds_write_b128 v4, v[148:151] offset:18432
    s_sub_u32 s56, s40, 1
    s_and_b32 s56, s56, 3
    s_mul_i32 s56, s56, 24576
    v_add_u32 v49, s56, v68
    s_sub_u32 s56, s40, 2
    s_and_b32 s56, s56, 3
    s_mul_i32 s56, s56, 24576
    v_add_u32 v50, s56, v68
    s_sub_u32 s56, s40, 3
    s_and_b32 s56, s56, 3
    s_mul_i32 s56, s56, 24576
    v_add_u32 v51, s56, v68
    v_lshlrev_b32 v48, 3, v2
    v_add_u32 v48, s45, v48
    v_lshlrev_b32 v174, 16, v174
    s_mov_b32 s52, s26
    s_and_b32 s53, s27, 0xffff
    s_mov_b32 s54, 2621440
    s_mov_b32 s55, 0x00020000
    v_mov_b32 v3, 162092
    v_mov_b32 v5, 1
    s_waitcnt lgkmcnt(0)
    s_mov_b64 exec, 1
    ds_add_u32 v3, v5
    s_mov_b64 exec, -1
    v_mov_b32 v3, 162092
    s_mov_b32 s70, 0
LW_30:
    s_nop 4
    ds_read_b32 v5, v3
    s_add_u32 s70, s70, 1
    s_waitcnt lgkmcnt(0)
    v_readfirstlane_b32 s71, v5
    s_cmp_gt_u32 s70, 262144
    s_cbranch_scc1 LWX_31
    s_cmp_ge_u32 s71, 8
    s_cbranch_scc1 LWX_31
    s_branch LW_30
LWX_31:
    s_nop 4
    ds_read_b64 v[226:227], v48 offset:8192
    ds_read_b64 v[228:229], v48 offset:8704
    ds_read_b64 v[230:231], v48 offset:9216
    ds_read_b64 v[232:233], v48 offset:9728
    ds_read_b64 v[234:235], v48 offset:10240
    ds_read_b128 v[76:79], v49 offset:0
    ds_read_b128 v[92:95], v49 offset:1024
    ds_read_b128 v[108:111], v49 offset:2048
    ds_read_b128 v[124:127], v49 offset:3072
    ds_read_b128 v[140:143], v49 offset:4096
    ds_read_b128 v[80:83], v50 offset:5120
    ds_read_b128 v[96:99], v50 offset:6144
    ds_read_b128 v[112:115], v50 offset:7168
    ds_read_b128 v[128:131], v50 offset:12288
    ds_read_b128 v[144:147], v50 offset:13312
    ds_read_b128 v[84:87], v51 offset:14336
    ds_read_b128 v[100:103], v51 offset:15360
    ds_read_b128 v[116:119], v51 offset:16384
    ds_read_b128 v[132:135], v51 offset:17408
    ds_read_b128 v[148:151], v51 offset:18432
    s_waitcnt lgkmcnt(15)
    v_lshlrev_b32 v8, 16, v226
    v_and_b32 v9, 0xffff0000, v226
    v_lshlrev_b32 v10, 16, v227
    v_and_b32 v11, 0xffff0000, v227
    v_lshlrev_b32 v12, 16, v228
    v_and_b32 v13, 0xffff0000, v228
    v_lshlrev_b32 v14, 16, v229
    v_and_b32 v15, 0xffff0000, v229
    v_lshlrev_b32 v16, 16, v230
    v_and_b32 v17, 0xffff0000, v230
    v_lshlrev_b32 v18, 16, v231
    v_and_b32 v19, 0xffff0000, v231
    v_lshlrev_b32 v20, 16, v232
    v_and_b32 v21, 0xffff0000, v232
    v_lshlrev_b32 v22, 16, v233
    v_and_b32 v23, 0xffff0000, v233
    v_lshlrev_b32 v24, 16, v234
    v_and_b32 v25, 0xffff0000, v234
    v_lshlrev_b32 v26, 16, v235
    v_and_b32 v27, 0xffff0000, v235
    s_waitcnt lgkmcnt(10)
    v_pk_add_f32 v[72:73], v[72:73], v[76:77]
    v_pk_add_f32 v[74:75], v[74:75], v[78:79]
    v_pk_add_f32 v[88:89], v[88:89], v[92:93]
    v_pk_add_f32 v[90:91], v[90:91], v[94:95]
    v_pk_add_f32 v[104:105], v[104:105], v[108:109]
    v_pk_add_f32 v[106:107], v[106:107], v[110:111]
    v_pk_add_f32 v[120:121], v[120:121], v[124:125]
    v_pk_add_f32 v[122:123], v[122:123], v[126:127]
    v_pk_add_f32 v[136:137], v[136:137], v[140:141]
    v_pk_add_f32 v[138:139], v[138:139], v[142:143]
    s_waitcnt lgkmcnt(5)
    v_pk_add_f32 v[72:73], v[72:73], v[80:81]
    v_pk_add_f32 v[74:75], v[74:75], v[82:83]
    v_pk_add_f32 v[88:89], v[88:89], v[96:97]
    v_pk_add_f32 v[90:91], v[90:91], v[98:99]
    v_pk_add_f32 v[104:105], v[104:105], v[112:113]
    v_pk_add_f32 v[106:107], v[106:107], v[114:115]
    v_pk_add_f32 v[120:121], v[120:121], v[128:129]
    v_pk_add_f32 v[122:123], v[122:123], v[130:131]
    v_pk_add_f32 v[136:137], v[136:137], v[144:145]
    v_pk_add_f32 v[138:139], v[138:139], v[146:147]
    s_waitcnt lgkmcnt(0)
    v_pk_add_f32 v[72:73], v[72:73], v[84:85]
    v_pk_add_f32 v[74:75], v[74:75], v[86:87]
    v_pk_add_f32 v[88:89], v[88:89], v[100:101]
    v_pk_add_f32 v[90:91], v[90:91], v[102:103]
    v_pk_add_f32 v[104:105], v[104:105], v[116:117]
    v_pk_add_f32 v[106:107], v[106:107], v[118:119]
    v_pk_add_f32 v[120:121], v[120:121], v[132:133]
    v_pk_add_f32 v[122:123], v[122:123], v[134:135]
    v_pk_add_f32 v[136:137], v[136:137], v[148:149]
    v_pk_add_f32 v[138:139], v[138:139], v[150:151]
    v_cvt_pk_bf16_f32 v216, v72, v73
    v_cvt_pk_bf16_f32 v217, v74, v75
    v_lshlrev_b32 v176, 16, v216
    v_and_b32 v177, 0xffff0000, v216
    v_lshlrev_b32 v178, 16, v217
    v_and_b32 v179, 0xffff0000, v217
    v_pk_add_f32 v[176:177], v[176:177], v[174:175] op_sel_hi:[1,0]
    v_pk_add_f32 v[178:179], v[178:179], v[174:175] op_sel_hi:[1,0]
    v_cvt_pk_bf16_f32 v216, v176, v177
    v_cvt_pk_bf16_f32 v217, v178, v179
    v_lshlrev_b32 v176, 16, v216
    v_and_b32 v177, 0xffff0000, v216
    v_lshlrev_b32 v178, 16, v217
    v_and_b32 v179, 0xffff0000, v217
    v_pk_add_f32 v[176:177], v[176:177], v[8:9]
    v_pk_add_f32 v[178:179], v[178:179], v[10:11]
    v_cvt_pk_bf16_f32 v216, v176, v177
    v_cvt_pk_bf16_f32 v217, v178, v179
    v_cvt_pk_bf16_f32 v218, v88, v89
    v_cvt_pk_bf16_f32 v219, v90, v91
    v_lshlrev_b32 v180, 16, v218
    v_and_b32 v181, 0xffff0000, v218
    v_lshlrev_b32 v182, 16, v219
    v_and_b32 v183, 0xffff0000, v219
    v_pk_add_f32 v[180:181], v[180:181], v[174:175] op_sel_hi:[1,0]
    v_pk_add_f32 v[182:183], v[182:183], v[174:175] op_sel_hi:[1,0]
    v_cvt_pk_bf16_f32 v218, v180, v181
    v_cvt_pk_bf16_f32 v219, v182, v183
    v_lshlrev_b32 v180, 16, v218
    v_and_b32 v181, 0xffff0000, v218
    v_lshlrev_b32 v182, 16, v219
    v_and_b32 v183, 0xffff0000, v219
    v_pk_add_f32 v[180:181], v[180:181], v[12:13]
    v_pk_add_f32 v[182:183], v[182:183], v[14:15]
    v_cvt_pk_bf16_f32 v218, v180, v181
    v_cvt_pk_bf16_f32 v219, v182, v183
    s_nop 0
    v_permlane16_swap_b32 v216, v218
    v_permlane16_swap_b32 v217, v219
    buffer_store_dwordx4 v[216:219], v67, s[52:55], s61 offen offset:0
    v_cvt_pk_bf16_f32 v220, v104, v105
    v_cvt_pk_bf16_f32 v221, v106, v107
    v_lshlrev_b32 v184, 16, v220
    v_and_b32 v185, 0xffff0000, v220
    v_lshlrev_b32 v186, 16, v221
    v_and_b32 v187, 0xffff0000, v221
    v_pk_add_f32 v[184:185], v[184:185], v[174:175] op_sel_hi:[1,0]
    v_pk_add_f32 v[186:187], v[186:187], v[174:175] op_sel_hi:[1,0]
    v_cvt_pk_bf16_f32 v220, v184, v185
    v_cvt_pk_bf16_f32 v221, v186, v187
    v_lshlrev_b32 v184, 16, v220
    v_and_b32 v185, 0xffff0000, v220
    v_lshlrev_b32 v186, 16, v221
    v_and_b32 v187, 0xffff0000, v221
    v_pk_add_f32 v[184:185], v[184:185], v[16:17]
    v_pk_add_f32 v[186:187], v[186:187], v[18:19]
    v_cvt_pk_bf16_f32 v220, v184, v185
    v_cvt_pk_bf16_f32 v221, v186, v187
    v_cvt_pk_bf16_f32 v222, v120, v121
    v_cvt_pk_bf16_f32 v223, v122, v123
    v_lshlrev_b32 v188, 16, v222
    v_and_b32 v189, 0xffff0000, v222
    v_lshlrev_b32 v190, 16, v223
    v_and_b32 v191, 0xffff0000, v223
    v_pk_add_f32 v[188:189], v[188:189], v[174:175] op_sel_hi:[1,0]
    v_pk_add_f32 v[190:191], v[190:191], v[174:175] op_sel_hi:[1,0]
    v_cvt_pk_bf16_f32 v222, v188, v189
    v_cvt_pk_bf16_f32 v223, v190, v191
    v_lshlrev_b32 v188, 16, v222
    v_and_b32 v189, 0xffff0000, v222
    v_lshlrev_b32 v190, 16, v223
    v_and_b32 v191, 0xffff0000, v223
    v_pk_add_f32 v[188:189], v[188:189], v[20:21]
    v_pk_add_f32 v[190:191], v[190:191], v[22:23]
    v_cvt_pk_bf16_f32 v222, v188, v189
    v_cvt_pk_bf16_f32 v223, v190, v191
    s_nop 0
    v_permlane16_swap_b32 v220, v222
    v_permlane16_swap_b32 v221, v223
    buffer_store_dwordx4 v[220:223], v67, s[52:55], s61 offen offset:64
    v_cvt_pk_bf16_f32 v224, v136, v137
    v_cvt_pk_bf16_f32 v225, v138, v139
    v_lshlrev_b32 v192, 16, v224
    v_and_b32 v193, 0xffff0000, v224
    v_lshlrev_b32 v194, 16, v225
    v_and_b32 v195, 0xffff0000, v225
    v_pk_add_f32 v[192:193], v[192:193], v[174:175] op_sel_hi:[1,0]
    v_pk_add_f32 v[194:195], v[194:195], v[174:175] op_sel_hi:[1,0]
    v_cvt_pk_bf16_f32 v224, v192, v193
    v_cvt_pk_bf16_f32 v225, v194, v195
    v_lshlrev_b32 v192, 16, v224
    v_and_b32 v193, 0xffff0000, v224
    v_lshlrev_b32 v194, 16, v225
    v_and_b32 v195, 0xffff0000, v225
    v_pk_add_f32 v[192:193], v[192:193], v[24:25]
    v_pk_add_f32 v[194:195], v[194:195], v[26:27]
    v_cvt_pk_bf16_f32 v224, v192, v193
    v_cvt_pk_bf16_f32 v225, v194, v195
    buffer_store_dwordx2 v[224:225], v65, s[52:55], s61 offen offset:128
    s_endpgm
KF_AUX:
    s_nop 4
    s_lshl_b32 s67, s67, 2
    s_add_u32 s67, s67, s64
    v_mul_u32_u24 v56, 52, v2
    v_lshrrev_b32 v56, 8, v56
    v_mul_u32_u24 v57, 5, v56
    v_sub_u32 v57, v2, v57
    v_lshlrev_b32 v61, 5, v57
    s_mul_i32 s69, s67, 160
    s_mov_b32 s52, s10
    s_and_b32 s53, s11, 0xffff
    s_mov_b32 s54, 5120
    s_mov_b32 s55, 0x00020000
    buffer_load_dwordx4 v[102:105], v61, s[52:55], s69 offen
    buffer_load_dwordx4 v[106:109], v61, s[52:55], s69 offen offset:16
    s_waitcnt lgkmcnt(0)
    s_add_u32 s30, s30, 0x9E3779B9
    s_add_u32 s31, s31, 0x7F4A7C15
    v_mov_b32 v5, 162064
    v_mov_b32 v6, 1
    s_waitcnt lgkmcnt(0)
    s_mov_b64 exec, 1
    ds_add_u32 v5, v6
    s_mov_b64 exec, -1
    s_lshl_b32 s41, s64, 8
    s_sub_u32 s42, 255, s2
    s_add_u32 s41, s41, s42
    s_lshl_b32 s62, s41, 12
    v_mov_b32 v4, 0
    s_mov_b32 s36, s12
    s_and_b32 s37, s13, 0xffff
    s_mov_b32 s38, 2621440
    s_mov_b32 s39, 0x00020000
    s_movk_i32 s56, 160
    v_mul_u32_u24 v58, s56, v56
    v_lshl_add_u32 v58, v57, 3, v58
    s_mul_i32 s56, s64, 40
    s_add_u32 s56, s56, 110784
    v_add_u32 v58, s56, v58
    s_mul_i32 s42, s64, 4160
    s_add_u32 s42, s42, 98304
    s_mul_i32 s43, s64, 4608
    s_add_u32 s43, s43, 148224
    s_mov_b32 s32, s28
    s_and_b32 s33, s29, 0xffff
    s_mov_b32 s34, 10027008
    s_mov_b32 s35, 0x00020000
    v_lshrrev_b32 v12, 3, v2
    v_and_b32 v13, 7, v2
    v_lshlrev_b32 v9, 14, v12
    v_lshl_add_u32 v9, v13, 4, v9
    s_mul_i32 s57, s67, 81920
    s_lshl_b32 s56, s66, 7
    s_add_u32 s57, s57, s56
    s_add_u32 s57, s57, 2818048
    s_mul_i32 s58, s64, 768
    s_add_u32 s58, s58, 133312
    s_movk_i32 s56, 144
    v_mul_u32_u24 v10, s56, v57
    v_lshl_add_u32 v10, v56, 4, v10
    v_add_u32 v10, s58, v10
    v_mul_u32_u24 v11, s56, v12
    v_lshl_add_u32 v11, v13, 4, v11
    v_add_u32 v11, s58, v11
    buffer_load_dwordx4 v[192:195], v3, s[36:39], s62 offen offset:0
    buffer_load_dwordx4 v[196:199], v3, s[36:39], s62 offen offset:1024
    buffer_load_dwordx4 v[200:203], v3, s[36:39], s62 offen offset:2048
    buffer_load_dwordx4 v[204:207], v3, s[36:39], s62 offen offset:3072
    buffer_load_dwordx2 v[208:209], v3, s[36:39], s62 offen offset:16
    buffer_load_dwordx2 v[210:211], v3, s[36:39], s62 offen offset:1040
    buffer_load_dwordx2 v[212:213], v3, s[36:39], s62 offen offset:2064
    buffer_load_dwordx2 v[214:215], v3, s[36:39], s62 offen offset:3088
    s_mov_b32 s44, s14
    s_and_b32 s45, s15, 0xffff
    s_mov_b32 s46, 1280
    s_mov_b32 s47, 0x00020000
    s_lshl_b32 s56, s41, 1
    buffer_load_ushort v8, v4, s[44:47], s56 offen
    s_waitcnt vmcnt(9)
    v_mov_b32 v5, 162056
    v_mov_b32 v6, 1
    s_waitcnt lgkmcnt(0)
    s_mov_b64 exec, 1
    ds_add_u32 v5, v6
    s_mov_b64 exec, -1
    v_mov_b32 v5, 162056
    s_mov_b32 s70, 0
LW_32:
    s_nop 4
    ds_read_b32 v6, v5
    s_add_u32 s70, s70, 1
    s_waitcnt lgkmcnt(0)
    v_readfirstlane_b32 s71, v6
    s_cmp_gt_u32 s70, 262144
    s_cbranch_scc1 LWX_33
    s_cmp_ge_u32 s71, 4
    s_cbranch_scc1 LWX_33
    s_branch LW_32
LWX_33:
    s_nop 4
    s_mov_b32 exec_lo, 0xffffffff
    s_mov_b32 exec_hi, 0xff
    ds_read_b64 v[64:65], v58 offset:0
    ds_read_b64 v[66:67], v58 offset:1440
    ds_read_b64 v[68:69], v58 offset:2880
    ds_read_b64 v[70:71], v58 offset:4320
    ds_read_b64 v[72:73], v58 offset:5760
    ds_read_b64 v[74:75], v58 offset:7200
    ds_read_b64 v[76:77], v58 offset:8640
    ds_read_b64 v[78:79], v58 offset:10080
    ds_read_b64 v[80:81], v58 offset:160
    ds_read_b64 v[82:83], v58 offset:1600
    ds_read_b64 v[84:85], v58 offset:3040
    ds_read_b64 v[86:87], v58 offset:12288
    ds_read_b64 v[88:89], v58 offset:13568
    ds_read_b64 v[90:91], v58 offset:14848
    ds_read_b64 v[92:93], v58 offset:16128
    ds_read_b64 v[94:95], v58 offset:17408
    ds_read_b64 v[96:97], v58 offset:18688
    ds_read_b64 v[98:99], v58 offset:19968
    ds_read_b64 v[100:101], v58 offset:21248
    s_waitcnt lgkmcnt(0)
    v_lshlrev_b32 v112, 16, v102
    v_and_b32 v114, 0xffff0000, v102
    v_lshlrev_b32 v116, 16, v103
    v_and_b32 v118, 0xffff0000, v103
    v_lshlrev_b32 v113, 16, v104
    v_and_b32 v115, 0xffff0000, v104
    v_lshlrev_b32 v117, 16, v105
    v_and_b32 v119, 0xffff0000, v105
    v_lshlrev_b32 v120, 16, v64
    v_and_b32 v121, 0xffff0000, v64
    v_lshlrev_b32 v122, 16, v66
    v_and_b32 v123, 0xffff0000, v66
    v_lshlrev_b32 v124, 16, v68
    v_and_b32 v125, 0xffff0000, v68
    v_lshlrev_b32 v126, 16, v70
    v_and_b32 v127, 0xffff0000, v70
    v_lshlrev_b32 v128, 16, v72
    v_and_b32 v129, 0xffff0000, v72
    v_lshlrev_b32 v130, 16, v74
    v_and_b32 v131, 0xffff0000, v74
    v_lshlrev_b32 v132, 16, v76
    v_and_b32 v133, 0xffff0000, v76
    v_lshlrev_b32 v134, 16, v78
    v_and_b32 v135, 0xffff0000, v78
    v_lshlrev_b32 v136, 16, v80
    v_and_b32 v137, 0xffff0000, v80
    v_lshlrev_b32 v138, 16, v82
    v_and_b32 v139, 0xffff0000, v82
    v_lshlrev_b32 v140, 16, v84
    v_and_b32 v141, 0xffff0000, v84
    v_lshlrev_b32 v142, 16, v86
    v_and_b32 v143, 0xffff0000, v86
    v_lshlrev_b32 v144, 16, v88
    v_and_b32 v145, 0xffff0000, v88
    v_lshlrev_b32 v146, 16, v90
    v_and_b32 v147, 0xffff0000, v90
    v_lshlrev_b32 v148, 16, v92
    v_and_b32 v149, 0xffff0000, v92
    v_lshlrev_b32 v150, 16, v94
    v_and_b32 v151, 0xffff0000, v94
    v_lshlrev_b32 v152, 16, v96
    v_and_b32 v153, 0xffff0000, v96
    v_lshlrev_b32 v154, 16, v98
    v_and_b32 v155, 0xffff0000, v98
    v_lshlrev_b32 v156, 16, v100
    v_and_b32 v157, 0xffff0000, v100
    v_pk_mul_f32 v[120:121], v[120:121], v[118:119]
    v_pk_fma_f32 v[120:121], v[122:123], v[116:117], v[120:121]
    v_pk_fma_f32 v[120:121], v[124:125], v[114:115], v[120:121]
    v_pk_fma_f32 v[120:121], v[126:127], v[112:113], v[120:121]
    v_pk_mul_f32 v[122:123], v[122:123], v[118:119]
    v_pk_fma_f32 v[122:123], v[124:125], v[116:117], v[122:123]
    v_pk_fma_f32 v[122:123], v[126:127], v[114:115], v[122:123]
    v_pk_fma_f32 v[122:123], v[128:129], v[112:113], v[122:123]
    v_pk_mul_f32 v[124:125], v[124:125], v[118:119]
    v_pk_fma_f32 v[124:125], v[126:127], v[116:117], v[124:125]
    v_pk_fma_f32 v[124:125], v[128:129], v[114:115], v[124:125]
    v_pk_fma_f32 v[124:125], v[130:131], v[112:113], v[124:125]
    v_pk_mul_f32 v[126:127], v[126:127], v[118:119]
    v_pk_fma_f32 v[126:127], v[128:129], v[116:117], v[126:127]
    v_pk_fma_f32 v[126:127], v[130:131], v[114:115], v[126:127]
    v_pk_fma_f32 v[126:127], v[132:133], v[112:113], v[126:127]
    v_pk_mul_f32 v[128:129], v[128:129], v[118:119]
    v_pk_fma_f32 v[128:129], v[130:131], v[116:117], v[128:129]
    v_pk_fma_f32 v[128:129], v[132:133], v[114:115], v[128:129]
    v_pk_fma_f32 v[128:129], v[134:135], v[112:113], v[128:129]
    v_pk_mul_f32 v[130:131], v[130:131], v[118:119]
    v_pk_fma_f32 v[130:131], v[132:133], v[116:117], v[130:131]
    v_pk_fma_f32 v[130:131], v[134:135], v[114:115], v[130:131]
    v_pk_fma_f32 v[130:131], v[136:137], v[112:113], v[130:131]
    v_pk_mul_f32 v[132:133], v[132:133], v[118:119]
    v_pk_fma_f32 v[132:133], v[134:135], v[116:117], v[132:133]
    v_pk_fma_f32 v[132:133], v[136:137], v[114:115], v[132:133]
    v_pk_fma_f32 v[132:133], v[138:139], v[112:113], v[132:133]
    v_pk_mul_f32 v[134:135], v[134:135], v[118:119]
    v_pk_fma_f32 v[134:135], v[136:137], v[116:117], v[134:135]
    v_pk_fma_f32 v[134:135], v[138:139], v[114:115], v[134:135]
    v_pk_fma_f32 v[134:135], v[140:141], v[112:113], v[134:135]
    v_pk_mul_f32 v[142:143], v[142:143], v[120:121]
    v_pk_mul_f32 v[144:145], v[144:145], v[122:123]
    v_pk_mul_f32 v[146:147], v[146:147], v[124:125]
    v_pk_mul_f32 v[148:149], v[148:149], v[126:127]
    v_pk_mul_f32 v[150:151], v[150:151], v[128:129]
    v_pk_mul_f32 v[152:153], v[152:153], v[130:131]
    v_pk_mul_f32 v[154:155], v[154:155], v[132:133]
    v_pk_mul_f32 v[156:157], v[156:157], v[134:135]
    v_cvt_pk_bf16_f32 v160, v156, v154
    v_cvt_pk_bf16_f32 v161, v152, v150
    v_cvt_pk_bf16_f32 v162, v148, v146
    v_cvt_pk_bf16_f32 v163, v144, v142
    ds_write_b128 v10, v[160:163]
    ds_read_b128 v[160:163], v11
    v_cvt_pk_bf16_f32 v164, v157, v155
    v_cvt_pk_bf16_f32 v165, v153, v151
    v_cvt_pk_bf16_f32 v166, v149, v147
    v_cvt_pk_bf16_f32 v167, v145, v143
    ds_write_b128 v10, v[164:167]
    ds_read_b128 v[164:167], v11
    v_lshlrev_b32 v112, 16, v106
    v_and_b32 v114, 0xffff0000, v106
    v_lshlrev_b32 v116, 16, v107
    v_and_b32 v118, 0xffff0000, v107
    v_lshlrev_b32 v113, 16, v108
    v_and_b32 v115, 0xffff0000, v108
    v_lshlrev_b32 v117, 16, v109
    v_and_b32 v119, 0xffff0000, v109
    v_lshlrev_b32 v120, 16, v65
    v_and_b32 v121, 0xffff0000, v65
    v_lshlrev_b32 v122, 16, v67
    v_and_b32 v123, 0xffff0000, v67
    v_lshlrev_b32 v124, 16, v69
    v_and_b32 v125, 0xffff0000, v69
    v_lshlrev_b32 v126, 16, v71
    v_and_b32 v127, 0xffff0000, v71
    v_lshlrev_b32 v128, 16, v73
    v_and_b32 v129, 0xffff0000, v73
    v_lshlrev_b32 v130, 16, v75
    v_and_b32 v131, 0xffff0000, v75
    v_lshlrev_b32 v132, 16, v77
    v_and_b32 v133, 0xffff0000, v77
    v_lshlrev_b32 v134, 16, v79
    v_and_b32 v135, 0xffff0000, v79
    v_lshlrev_b32 v136, 16, v81
    v_and_b32 v137, 0xffff0000, v81
    v_lshlrev_b32 v138, 16, v83
    v_and_b32 v139, 0xffff0000, v83
    v_lshlrev_b32 v140, 16, v85
    v_and_b32 v141, 0xffff0000, v85
    v_lshlrev_b32 v142, 16, v87
    v_and_b32 v143, 0xffff0000, v87
    v_lshlrev_b32 v144, 16, v89
    v_and_b32 v145, 0xffff0000, v89
    v_lshlrev_b32 v146, 16, v91
    v_and_b32 v147, 0xffff0000, v91
    v_lshlrev_b32 v148, 16, v93
    v_and_b32 v149, 0xffff0000, v93
    v_lshlrev_b32 v150, 16, v95
    v_and_b32 v151, 0xffff0000, v95
    v_lshlrev_b32 v152, 16, v97
    v_and_b32 v153, 0xffff0000, v97
    v_lshlrev_b32 v154, 16, v99
    v_and_b32 v155, 0xffff0000, v99
    v_lshlrev_b32 v156, 16, v101
    v_and_b32 v157, 0xffff0000, v101
    v_pk_mul_f32 v[120:121], v[120:121], v[118:119]
    v_pk_fma_f32 v[120:121], v[122:123], v[116:117], v[120:121]
    v_pk_fma_f32 v[120:121], v[124:125], v[114:115], v[120:121]
    v_pk_fma_f32 v[120:121], v[126:127], v[112:113], v[120:121]
    v_pk_mul_f32 v[122:123], v[122:123], v[118:119]
    v_pk_fma_f32 v[122:123], v[124:125], v[116:117], v[122:123]
    v_pk_fma_f32 v[122:123], v[126:127], v[114:115], v[122:123]
    v_pk_fma_f32 v[122:123], v[128:129], v[112:113], v[122:123]
    v_pk_mul_f32 v[124:125], v[124:125], v[118:119]
    v_pk_fma_f32 v[124:125], v[126:127], v[116:117], v[124:125]
    v_pk_fma_f32 v[124:125], v[128:129], v[114:115], v[124:125]
    v_pk_fma_f32 v[124:125], v[130:131], v[112:113], v[124:125]
    v_pk_mul_f32 v[126:127], v[126:127], v[118:119]
    v_pk_fma_f32 v[126:127], v[128:129], v[116:117], v[126:127]
    v_pk_fma_f32 v[126:127], v[130:131], v[114:115], v[126:127]
    v_pk_fma_f32 v[126:127], v[132:133], v[112:113], v[126:127]
    v_pk_mul_f32 v[128:129], v[128:129], v[118:119]
    v_pk_fma_f32 v[128:129], v[130:131], v[116:117], v[128:129]
    v_pk_fma_f32 v[128:129], v[132:133], v[114:115], v[128:129]
    v_pk_fma_f32 v[128:129], v[134:135], v[112:113], v[128:129]
    v_pk_mul_f32 v[130:131], v[130:131], v[118:119]
    v_pk_fma_f32 v[130:131], v[132:133], v[116:117], v[130:131]
    v_pk_fma_f32 v[130:131], v[134:135], v[114:115], v[130:131]
    v_pk_fma_f32 v[130:131], v[136:137], v[112:113], v[130:131]
    v_pk_mul_f32 v[132:133], v[132:133], v[118:119]
    v_pk_fma_f32 v[132:133], v[134:135], v[116:117], v[132:133]
    v_pk_fma_f32 v[132:133], v[136:137], v[114:115], v[132:133]
    v_pk_fma_f32 v[132:133], v[138:139], v[112:113], v[132:133]
    v_pk_mul_f32 v[134:135], v[134:135], v[118:119]
    v_pk_fma_f32 v[134:135], v[136:137], v[116:117], v[134:135]
    v_pk_fma_f32 v[134:135], v[138:139], v[114:115], v[134:135]
    v_pk_fma_f32 v[134:135], v[140:141], v[112:113], v[134:135]
    v_pk_mul_f32 v[142:143], v[142:143], v[120:121]
    v_pk_mul_f32 v[144:145], v[144:145], v[122:123]
    v_pk_mul_f32 v[146:147], v[146:147], v[124:125]
    v_pk_mul_f32 v[148:149], v[148:149], v[126:127]
    v_pk_mul_f32 v[150:151], v[150:151], v[128:129]
    v_pk_mul_f32 v[152:153], v[152:153], v[130:131]
    v_pk_mul_f32 v[154:155], v[154:155], v[132:133]
    v_pk_mul_f32 v[156:157], v[156:157], v[134:135]
    v_cvt_pk_bf16_f32 v168, v156, v154
    v_cvt_pk_bf16_f32 v169, v152, v150
    v_cvt_pk_bf16_f32 v170, v148, v146
    v_cvt_pk_bf16_f32 v171, v144, v142
    ds_write_b128 v10, v[168:171]
    ds_read_b128 v[168:171], v11
    v_cvt_pk_bf16_f32 v172, v157, v155
    v_cvt_pk_bf16_f32 v173, v153, v151
    v_cvt_pk_bf16_f32 v174, v149, v147
    v_cvt_pk_bf16_f32 v175, v145, v143
    ds_write_b128 v10, v[172:175]
    ds_read_b128 v[172:175], v11
    s_waitcnt lgkmcnt(0)
    buffer_store_dwordx4 v[160:163], v9, s[32:35], s57 offen sc1
    s_add_u32 s57, s57, 4096
    buffer_store_dwordx4 v[164:167], v9, s[32:35], s57 offen sc1
    s_add_u32 s57, s57, 4096
    buffer_store_dwordx4 v[168:171], v9, s[32:35], s57 offen sc1
    s_add_u32 s57, s57, 4096
    buffer_store_dwordx4 v[172:175], v9, s[32:35], s57 offen sc1
    s_add_u32 s57, s57, 4096
    s_mov_b64 exec, -1
    v_mov_b32 v5, 162060
    v_mov_b32 v6, 1
    s_waitcnt lgkmcnt(0)
    s_mov_b64 exec, 1
    ds_add_u32 v5, v6
    s_mov_b64 exec, -1
    s_lshl_b32 s59, s67, 5
    s_add_u32 s59, s59, s66
    s_mul_i32 s59, s59, 16
    s_add_u32 s59, s59, 65536
    s_cmp_ge_u32 s41, 640
    s_cbranch_scc1 KF_NOCONV
    s_waitcnt vmcnt(0)
    v_mov_b32 v12, s30
    v_mov_b32 v13, s31
    v_mov_b32 v14, 0
    s_mov_b64 exec, 1
    buffer_store_dwordx2 v[12:13], v14, s[32:35], s59 offen sc1
    s_mov_b64 exec, -1
    v_mov_b32 v5, 162076
    v_mov_b32 v6, 1
    s_waitcnt lgkmcnt(0)
    s_mov_b64 exec, 1
    ds_add_u32 v5, v6
    s_mov_b64 exec, -1
    v_mov_b32 v5, 162060
    s_mov_b32 s70, 0
LW_34:
    s_nop 4
    ds_read_b32 v6, v5
    s_add_u32 s70, s70, 1
    s_waitcnt lgkmcnt(0)
    v_readfirstlane_b32 s71, v6
    s_cmp_gt_u32 s70, 262144
    s_cbranch_scc1 LWX_35
    s_cmp_ge_u32 s71, 4
    s_cbranch_scc1 LWX_35
    s_branch LW_34
LWX_35:
    s_nop 4
    v_mov_b32 v5, 162068
    s_mov_b32 s70, 0
LW_36:
    s_nop 4
    ds_read_b32 v6, v5
    s_add_u32 s70, s70, 1
    s_waitcnt lgkmcnt(0)
    v_readfirstlane_b32 s71, v6
    s_cmp_gt_u32 s70, 262144
    s_cbranch_scc1 LWX_37
    s_cmp_ge_u32 s71, 4
    s_cbranch_scc1 LWX_37
    s_branch LW_36
LWX_37:
    s_nop 4
    s_waitcnt vmcnt(0)
    v_add_u32 v9, s42, v3
    ds_write_b128 v9, v[192:195] offset:32
    v_alignbit_b32 v216, v193, v192, 16
    v_alignbit_b32 v217, v194, v193, 16
    v_alignbit_b32 v218, v195, v194, 16
    v_alignbit_b32 v219, v208, v195, 16
    v_mov_b32 v220, v193
    v_mov_b32 v221, v194
    v_mov_b32 v222, v195
    v_mov_b32 v223, v208
    v_alignbit_b32 v224, v194, v193, 16
    v_alignbit_b32 v225, v195, v194, 16
    v_alignbit_b32 v226, v208, v195, 16
    v_alignbit_b32 v227, v209, v208, 16
    ds_write_b128 v9, v[216:219] offset:12512
    ds_write_b128 v9, v[220:223] offset:24992
    ds_write_b128 v9, v[224:227] offset:37472
    ds_write_b128 v9, v[196:199] offset:1056
    v_alignbit_b32 v228, v197, v196, 16
    v_alignbit_b32 v229, v198, v197, 16
    v_alignbit_b32 v230, v199, v198, 16
    v_alignbit_b32 v231, v210, v199, 16
    v_mov_b32 v232, v197
    v_mov_b32 v233, v198
    v_mov_b32 v234, v199
    v_mov_b32 v235, v210
    v_alignbit_b32 v236, v198, v197, 16
    v_alignbit_b32 v237, v199, v198, 16
    v_alignbit_b32 v238, v210, v199, 16
    v_alignbit_b32 v239, v211, v210, 16
    ds_write_b128 v9, v[228:231] offset:13536
    ds_write_b128 v9, v[232:235] offset:26016
    ds_write_b128 v9, v[236:239] offset:38496
    ds_write_b128 v9, v[200:203] offset:2080
    v_alignbit_b32 v216, v201, v200, 16
    v_alignbit_b32 v217, v202, v201, 16
    v_alignbit_b32 v218, v203, v202, 16
    v_alignbit_b32 v219, v212, v203, 16
    v_mov_b32 v220, v201
    v_mov_b32 v221, v202
    v_mov_b32 v222, v203
    v_mov_b32 v223, v212
    v_alignbit_b32 v224, v202, v201, 16
    v_alignbit_b32 v225, v203, v202, 16
    v_alignbit_b32 v226, v212, v203, 16
    v_alignbit_b32 v227, v213, v212, 16
    ds_write_b128 v9, v[216:219] offset:14560
    ds_write_b128 v9, v[220:223] offset:27040
    ds_write_b128 v9, v[224:227] offset:39520
    ds_write_b128 v9, v[204:207] offset:3104
    v_alignbit_b32 v228, v205, v204, 16
    v_alignbit_b32 v229, v206, v205, 16
    v_alignbit_b32 v230, v207, v206, 16
    v_alignbit_b32 v231, v214, v207, 16
    v_mov_b32 v232, v205
    v_mov_b32 v233, v206
    v_mov_b32 v234, v207
    v_mov_b32 v235, v214
    v_alignbit_b32 v236, v206, v205, 16
    v_alignbit_b32 v237, v207, v206, 16
    v_alignbit_b32 v238, v214, v207, 16
    v_alignbit_b32 v239, v215, v214, 16
    ds_write_b128 v9, v[228:231] offset:15584
    ds_write_b128 v9, v[232:235] offset:28064
    ds_write_b128 v9, v[236:239] offset:40544
    v_readfirstlane_b32 s60, v192
    v_readfirstlane_b32 s61, v193
    s_nop 0
    v_mov_b32 v6, s60
    v_mov_b32 v7, s61
    v_lshlrev_b32 v9, 3, v2
    v_add_u32 v9, s43, v9
    v_mov_b32 v5, 0
    ds_write_b64 v9, v[4:5]
    v_and_b32 v11, 15, v2
    v_lshrrev_b32 v12, 4, v2
    v_add_u32 v13, 1, v11
    v_and_b32 v14, 3, v13
    s_movk_i32 s56, 12480
    v_mul_u32_u24 v10, s56, v14
    v_and_b32 v14, 0x1c, v13
    v_lshl_add_u32 v10, v14, 1, v10
    v_lshl_add_u32 v10, v12, 4, v10
    v_add_u32 v10, s42, v10
    v_lshlrev_b32 v15, 1, v11
    v_sub_u32 v15, v15, v12
    v_lshlrev_b32 v15, 4, v15
    s_add_u32 s57, s43, 80
    v_add_u32 v15, s57, v15
    v_lshrrev_b32 v16, 2, v2
    v_and_b32 v17, 3, v2
    v_mul_u32_u24 v18, s56, v16
    v_lshl_add_u32 v18, v17, 3, v18
    v_add_u32 v18, s42, v18
    v_lshlrev_b32 v19, 4, v16
    v_sub_u32 v19, 64, v19
    v_lshlrev_b32 v20, 3, v12
    v_add_u32 v20, v20, v11
    v_sub_u32 v20, 15, v20
    v_and_b32 v21, 1, v20
    v_lshlrev_b32 v21, 4, v21
    v_lshrrev_b32 v20, 1, v20
    v_lshlrev_b32 v22, 5, v11
    v_lshl_add_u32 v22, v12, 3, v22
    s_lshr_b32 s56, s2, 3
    s_lshr_b32 s65, s56, 2
    s_and_b32 s66, s56, 3
    s_and_b32 s56, s2, 7
    s_lshl_b32 s56, s56, 2
    s_add_u32 s66, s66, s56
    s_lshl_b32 s68, s66, 6
    s_lshl_b32 s56, s64, 4
    s_add_u32 s68, s68, s56
    s_mul_i32 s67, s64, 24576
    s_mul_i32 s59, s41, 3277
    s_lshr_b32 s59, s59, 16
    s_mul_i32 s59, s59, 512
    s_add_u32 s59, s59, 65536
    v_lshl_add_u32 v23, v2, 4, s59
    s_lshr_b32 s59, s68, 5
    s_mul_i32 s59, s59, 64
    s_add_u32 s59, s59, 91648
    v_lshl_add_u32 v28, v2, 4, s59
    v_cmp_gt_u32 vcc, 32, v2
    s_nop 1
    v_cndmask_b32 v23, v28, v23, vcc
    s_mov_b32 s59, 0
    v_mov_b32 v28, 162080
    s_mov_b32 s70, 0
LW_38:
    s_nop 4
    ds_read_b32 v29, v28
    s_add_u32 s70, s70, 1
    s_waitcnt lgkmcnt(0)
    v_readfirstlane_b32 s71, v29
    s_cmp_gt_u32 s70, 262144
    s_cbranch_scc1 LWX_39
    s_cmp_ge_u32 s71, 4
    s_cbranch_scc1 LWX_39
    s_sleep 2
    s_branch LW_38
LWX_39:
    s_nop 4
    s_mov_b32 s70, 0
    s_mov_b32 exec_lo, 0xffffffff
    s_mov_b32 exec_hi, 0xf
POLL_40:
    s_nop 4
    buffer_load_dwordx2 v[28:29], v23, s[32:35], s59 offen sc1
    s_add_u32 s70, s70, 1
    s_waitcnt vmcnt(0)
    v_cmp_ne_u64 vcc, s[30:31], v[28:29]
    s_cmp_gt_u32 s70, 65536
    s_cbranch_scc1 POLLX_41
    s_cbranch_vccz POLLX_41
    s_sleep 6
    s_branch POLL_40
POLLX_41:
    s_nop 4
    s_mov_b64 exec, -1
    v_and_b32 v232, 15, v2
    v_lshrrev_b32 v233, 2, v232
    v_lshlrev_b32 v233, 6, v233
    v_and_b32 v234, 3, v232
    v_lshl_add_u32 v239, v234, 3, v233
    s_lshr_b32 s59, s68, 5
    s_lshl_b32 s59, s59, 8
    s_and_b32 s56, s68, 16
    s_lshl_b32 s56, s56, 1
    s_add_u32 s59, s59, s56
    s_add_u32 s59, s59, 133120
    buffer_load_dwordx2 v[232:233], v239, s[32:35], s59 offen sc1
    s_add_u32 m0, s43, 512
    s_add_u32 s57, s62, 2818048
    buffer_load_dwordx4 v3, s[32:35], s57 offen offset:0 sc1 lds
    buffer_load_dwordx4 v3, s[32:35], s57 offen offset:1024 sc1 lds
    buffer_load_dwordx4 v3, s[32:35], s57 offen offset:2048 sc1 lds
    buffer_load_dwordx4 v3, s[32:35], s57 offen offset:3072 sc1 lds
    v_lshlrev_b64 v[6:7], v19, v[6:7]
    s_mov_b32 s60, 0x8880
    s_mov_b32 s61, 0
    v_cndmask_b32 v6, 0, v6, s[60:61]
    v_cndmask_b32 v7, 0, v7, s[60:61]
    s_mov_b64 exec, 0xffff
    ds_write_b64 v18, v[6:7]
    s_mov_b64 exec, -1
    v_lshlrev_b32 v8, v21, v8
    v_cmp_eq_u32 vcc, 0, v20
    s_nop 1
    v_cndmask_b32 v24, 0, v8, vcc
    v_cmp_eq_u32 vcc, 1, v20
    s_nop 1
    v_cndmask_b32 v25, 0, v8, vcc
    v_cmp_eq_u32 vcc, 2, v20
    s_nop 1
    v_cndmask_b32 v26, 0, v8, vcc
    v_cmp_eq_u32 vcc, 3, v20
    s_nop 1
    v_cndmask_b32 v27, 0, v8, vcc
    ds_read_b64 v[64:65], v10 offset:0
    ds_read_b64 v[66:67], v10 offset:8
    ds_read_b64 v[68:69], v10 offset:512
    ds_read_b64 v[70:71], v10 offset:520
    ds_read_b64 v[72:73], v10 offset:1024
    ds_read_b64 v[74:75], v10 offset:1032
    ds_read_b64 v[76:77], v10 offset:1536
    ds_read_b64 v[78:79], v10 offset:1544
    ds_read_b64 v[80:81], v10 offset:2048
    ds_read_b64 v[82:83], v10 offset:2056
    ds_read_b64 v[84:85], v10 offset:2560
    ds_read_b64 v[86:87], v10 offset:2568
    ds_read_b64 v[88:89], v10 offset:3072
    ds_read_b64 v[90:91], v10 offset:3080
    ds_read_b64 v[92:93], v10 offset:3584
    ds_read_b64 v[94:95], v10 offset:3592
    s_setprio 0
    s_waitcnt vmcnt(0)
    ds_read_b128 v[128:131], v15 offset:448
    ds_read_b128 v[132:135], v15 offset:960
    ds_read_b128 v[136:139], v15 offset:1472
    ds_read_b128 v[140:143], v15 offset:1984
    ds_read_b128 v[144:147], v15 offset:2496
    ds_read_b128 v[148:151], v15 offset:3008
    ds_read_b128 v[152:155], v15 offset:3520
    ds_read_b128 v[156:159], v15 offset:4032
    v_mov_b32 v30, 162072
    ds_read_b32 v31, v30
    s_waitcnt lgkmcnt(0)
    v_readfirstlane_b32 s56, v31
    s_nop 0
    s_cmp_lt_u32 s56, 52
    s_cbranch_scc1 NOY_42
    v_mov_b32 v5, 162084
    s_mov_b32 s70, 0
LW_43:
    s_nop 4
    ds_read_b32 v6, v5
    s_add_u32 s70, s70, 1
    s_waitcnt lgkmcnt(0)
    v_readfirstlane_b32 s71, v6
    s_cmp_gt_u32 s70, 262144
    s_cbranch_scc1 LWX_44
    s_cmp_ge_u32 s71, 4
    s_cbranch_scc1 LWX_44
    s_sleep 8
    s_branch LW_43
LWX_44:
    s_nop 4
NOY_42:
    s_nop 4
    v_mfma_f32_16x16x32_bf16 v[32:35], v[24:27], v[128:131], 0
    ds_read_b128 v[160:163], v15 offset:384
    v_mfma_f32_16x16x32_bf16 v[36:39], v[24:27], v[132:135], 0
    v_mfma_f32_16x16x32_bf16 v[40:43], v[24:27], v[136:139], 0
    ds_read_b128 v[164:167], v15 offset:896
    v_mfma_f32_16x16x32_bf16 v[44:47], v[24:27], v[140:143], 0
    v_mfma_f32_16x16x32_bf16 v[48:51], v[24:27], v[144:147], 0
    ds_read_b128 v[168:171], v15 offset:1408
    v_mfma_f32_16x16x32_bf16 v[52:55], v[24:27], v[148:151], 0
    v_mfma_f32_16x16x32_bf16 v[56:59], v[24:27], v[152:155], 0
    ds_read_b128 v[172:175], v15 offset:1920
    v_mfma_f32_16x16x32_bf16 v[60:63], v[24:27], v[156:159], 0
    v_mfma_f32_16x16x32_bf16 v[32:35], v[64:67], v[128:131], v[32:35]
    ds_read_b128 v[176:179], v15 offset:2432
    v_mfma_f32_16x16x32_bf16 v[36:39], v[64:67], v[132:135], v[36:39]
    v_mfma_f32_16x16x32_bf16 v[40:43], v[64:67], v[136:139], v[40:43]
    ds_read_b128 v[180:183], v15 offset:2944
    v_mfma_f32_16x16x32_bf16 v[44:47], v[64:67], v[140:143], v[44:47]
    v_mfma_f32_16x16x32_bf16 v[48:51], v[64:67], v[144:147], v[48:51]
    ds_read_b128 v[184:187], v15 offset:3456
    v_mfma_f32_16x16x32_bf16 v[52:55], v[64:67], v[148:151], v[52:55]
    v_mfma_f32_16x16x32_bf16 v[56:59], v[64:67], v[152:155], v[56:59]
    ds_read_b128 v[188:191], v15 offset:3968
    v_mfma_f32_16x16x32_bf16 v[60:63], v[64:67], v[156:159], v[60:63]
    v_mfma_f32_16x16x32_bf16 v[36:39], v[68:71], v[128:131], v[36:39]
    ds_read_b64 v[96:97], v10 offset:64
    ds_read_b64 v[98:99], v10 offset:72
    v_mfma_f32_16x16x32_bf16 v[40:43], v[68:71], v[132:135], v[40:43]
    v_mfma_f32_16x16x32_bf16 v[44:47], v[68:71], v[136:139], v[44:47]
    ds_read_b64 v[100:101], v10 offset:576
    ds_read_b64 v[102:103], v10 offset:584
    v_mfma_f32_16x16x32_bf16 v[48:51], v[68:71], v[140:143], v[48:51]
    v_mfma_f32_16x16x32_bf16 v[52:55], v[68:71], v[144:147], v[52:55]
    ds_read_b64 v[104:105], v10 offset:1088
    ds_read_b64 v[106:107], v10 offset:1096
    v_mfma_f32_16x16x32_bf16 v[56:59], v[68:71], v[148:151], v[56:59]
    v_mfma_f32_16x16x32_bf16 v[60:63], v[68:71], v[152:155], v[60:63]
    ds_read_b64 v[108:109], v10 offset:1600
    ds_read_b64 v[110:111], v10 offset:1608
    v_mfma_f32_16x16x32_bf16 v[40:43], v[72:75], v[128:131], v[40:43]
    v_mfma_f32_16x16x32_bf16 v[44:47], v[72:75], v[132:135], v[44:47]
    ds_read_b64 v[112:113], v10 offset:2112
    ds_read_b64 v[114:115], v10 offset:2120
    v_mfma_f32_16x16x32_bf16 v[48:51], v[72:75], v[136:139], v[48:51]
    v_mfma_f32_16x16x32_bf16 v[52:55], v[72:75], v[140:143], v[52:55]
    ds_read_b64 v[116:117], v10 offset:2624
    ds_read_b64 v[118:119], v10 offset:2632
    v_mfma_f32_16x16x32_bf16 v[56:59], v[72:75], v[144:147], v[56:59]
    v_mfma_f32_16x16x32_bf16 v[60:63], v[72:75], v[148:151], v[60:63]
    ds_read_b64 v[120:121], v10 offset:3136
    ds_read_b64 v[122:123], v10 offset:3144
    v_mfma_f32_16x16x32_bf16 v[44:47], v[76:79], v[128:131], v[44:47]
    v_mfma_f32_16x16x32_bf16 v[48:51], v[76:79], v[132:135], v[48:51]
    ds_read_b64 v[124:125], v10 offset:3648
    ds_read_b64 v[126:127], v10 offset:3656
    v_mfma_f32_16x16x32_bf16 v[52:55], v[76:79], v[136:139], v[52:55]
    v_mfma_f32_16x16x32_bf16 v[56:59], v[76:79], v[140:143], v[56:59]
    v_mfma_f32_16x16x32_bf16 v[60:63], v[76:79], v[144:147], v[60:63]
    v_mfma_f32_16x16x32_bf16 v[48:51], v[80:83], v[128:131], v[48:51]
    v_mfma_f32_16x16x32_bf16 v[52:55], v[80:83], v[132:135], v[52:55]
    v_mfma_f32_16x16x32_bf16 v[56:59], v[80:83], v[136:139], v[56:59]
    v_mfma_f32_16x16x32_bf16 v[60:63], v[80:83], v[140:143], v[60:63]
    v_mfma_f32_16x16x32_bf16 v[52:55], v[84:87], v[128:131], v[52:55]
    v_mfma_f32_16x16x32_bf16 v[56:59], v[84:87], v[132:135], v[56:59]
    v_mfma_f32_16x16x32_bf16 v[60:63], v[84:87], v[136:139], v[60:63]
    v_mfma_f32_16x16x32_bf16 v[56:59], v[88:91], v[128:131], v[56:59]
    ds_read_b32 v31, v30
    v_mfma_f32_16x16x32_bf16 v[60:63], v[88:91], v[132:135], v[60:63]
    v_mfma_f32_16x16x32_bf16 v[60:63], v[92:95], v[128:131], v[60:63]
    s_waitcnt lgkmcnt(0)
    v_readfirstlane_b32 s56, v31
    s_nop 0
    s_cmp_lt_u32 s56, 52
    s_cbranch_scc1 NOY_45
    v_mov_b32 v5, 162084
    s_mov_b32 s70, 0
LW_46:
    s_nop 4
    ds_read_b32 v6, v5
    s_add_u32 s70, s70, 1
    s_waitcnt lgkmcnt(0)
    v_readfirstlane_b32 s71, v6
    s_cmp_gt_u32 s70, 262144
    s_cbranch_scc1 LWX_47
    s_cmp_ge_u32 s71, 4
    s_cbranch_scc1 LWX_47
    s_sleep 8
    s_branch LW_46
LWX_47:
    s_nop 4
NOY_45:
    s_nop 4
    v_mfma_f32_16x16x32_bf16 v[32:35], v[96:99], v[160:163], v[32:35]
    ds_read_b128 v[128:131], v15 offset:320
    v_mfma_f32_16x16x32_bf16 v[36:39], v[96:99], v[164:167], v[36:39]
    v_mfma_f32_16x16x32_bf16 v[40:43], v[96:99], v[168:171], v[40:43]
    ds_read_b128 v[132:135], v15 offset:832
    v_mfma_f32_16x16x32_bf16 v[44:47], v[96:99], v[172:175], v[44:47]
    v_mfma_f32_16x16x32_bf16 v[48:51], v[96:99], v[176:179], v[48:51]
    ds_read_b128 v[136:139], v15 offset:1344
    v_mfma_f32_16x16x32_bf16 v[52:55], v[96:99], v[180:183], v[52:55]
    v_mfma_f32_16x16x32_bf16 v[56:59], v[96:99], v[184:187], v[56:59]
    ds_read_b128 v[140:143], v15 offset:1856
    v_mfma_f32_16x16x32_bf16 v[60:63], v[96:99], v[188:191], v[60:63]
    v_mfma_f32_16x16x32_bf16 v[36:39], v[100:103], v[160:163], v[36:39]
    ds_read_b128 v[144:147], v15 offset:2368
    v_mfma_f32_16x16x32_bf16 v[40:43], v[100:103], v[164:167], v[40:43]
    v_mfma_f32_16x16x32_bf16 v[44:47], v[100:103], v[168:171], v[44:47]
    ds_read_b128 v[148:151], v15 offset:2880
    v_mfma_f32_16x16x32_bf16 v[48:51], v[100:103], v[172:175], v[48:51]
    v_mfma_f32_16x16x32_bf16 v[52:55], v[100:103], v[176:179], v[52:55]
    ds_read_b128 v[152:155], v15 offset:3392
    v_mfma_f32_16x16x32_bf16 v[56:59], v[100:103], v[180:183], v[56:59]
    v_mfma_f32_16x16x32_bf16 v[60:63], v[100:103], v[184:187], v[60:63]
    ds_read_b128 v[156:159], v15 offset:3904
    v_mfma_f32_16x16x32_bf16 v[40:43], v[104:107], v[160:163], v[40:43]
    v_mfma_f32_16x16x32_bf16 v[44:47], v[104:107], v[164:167], v[44:47]
    ds_read_b64 v[64:65], v10 offset:128
    ds_read_b64 v[66:67], v10 offset:136
    v_mfma_f32_16x16x32_bf16 v[48:51], v[104:107], v[168:171], v[48:51]
    v_mfma_f32_16x16x32_bf16 v[52:55], v[104:107], v[172:175], v[52:55]
    ds_read_b64 v[68:69], v10 offset:640
    ds_read_b64 v[70:71], v10 offset:648
    v_mfma_f32_16x16x32_bf16 v[56:59], v[104:107], v[176:179], v[56:59]
    v_mfma_f32_16x16x32_bf16 v[60:63], v[104:107], v[180:183], v[60:63]
    ds_read_b64 v[72:73], v10 offset:1152
    ds_read_b64 v[74:75], v10 offset:1160
    v_mfma_f32_16x16x32_bf16 v[44:47], v[108:111], v[160:163], v[44:47]
    v_mfma_f32_16x16x32_bf16 v[48:51], v[108:111], v[164:167], v[48:51]
    ds_read_b64 v[76:77], v10 offset:1664
    ds_read_b64 v[78:79], v10 offset:1672
    v_mfma_f32_16x16x32_bf16 v[52:55], v[108:111], v[168:171], v[52:55]
    v_mfma_f32_16x16x32_bf16 v[56:59], v[108:111], v[172:175], v[56:59]
    ds_read_b64 v[80:81], v10 offset:2176
    ds_read_b64 v[82:83], v10 offset:2184
    v_mfma_f32_16x16x32_bf16 v[60:63], v[108:111], v[176:179], v[60:63]
    v_mfma_f32_16x16x32_bf16 v[48:51], v[112:115], v[160:163], v[48:51]
    ds_read_b64 v[84:85], v10 offset:2688
    ds_read_b64 v[86:87], v10 offset:2696
    v_mfma_f32_16x16x32_bf16 v[52:55], v[112:115], v[164:167], v[52:55]
    v_mfma_f32_16x16x32_bf16 v[56:59], v[112:115], v[168:171], v[56:59]
    ds_read_b64 v[88:89], v10 offset:3200
    ds_read_b64 v[90:91], v10 offset:3208
    v_mfma_f32_16x16x32_bf16 v[60:63], v[112:115], v[172:175], v[60:63]
    v_mfma_f32_16x16x32_bf16 v[52:55], v[116:119], v[160:163], v[52:55]
    ds_read_b64 v[92:93], v10 offset:3712
    ds_read_b64 v[94:95], v10 offset:3720
    v_mfma_f32_16x16x32_bf16 v[56:59], v[116:119], v[164:167], v[56:59]
    v_mfma_f32_16x16x32_bf16 v[60:63], v[116:119], v[168:171], v[60:63]
    v_mfma_f32_16x16x32_bf16 v[56:59], v[120:123], v[160:163], v[56:59]
    ds_read_b32 v31, v30
    v_mfma_f32_16x16x32_bf16 v[60:63], v[120:123], v[164:167], v[60:63]
    v_mfma_f32_16x16x32_bf16 v[60:63], v[124:127], v[160:163], v[60:63]
    s_waitcnt lgkmcnt(0)
    v_readfirstlane_b32 s56, v31
    s_nop 0
    s_cmp_lt_u32 s56, 52
    s_cbranch_scc1 NOY_48
    v_mov_b32 v5, 162084
    s_mov_b32 s70, 0
LW_49:
    s_nop 4
    ds_read_b32 v6, v5
    s_add_u32 s70, s70, 1
    s_waitcnt lgkmcnt(0)
    v_readfirstlane_b32 s71, v6
    s_cmp_gt_u32 s70, 262144
    s_cbranch_scc1 LWX_50
    s_cmp_ge_u32 s71, 4
    s_cbranch_scc1 LWX_50
    s_sleep 8
    s_branch LW_49
LWX_50:
    s_nop 4
NOY_48:
    s_nop 4
    v_mfma_f32_16x16x32_bf16 v[32:35], v[64:67], v[128:131], v[32:35]
    ds_read_b128 v[160:163], v15 offset:256
    v_mfma_f32_16x16x32_bf16 v[36:39], v[64:67], v[132:135], v[36:39]
    v_mfma_f32_16x16x32_bf16 v[40:43], v[64:67], v[136:139], v[40:43]
    ds_read_b128 v[164:167], v15 offset:768
    v_mfma_f32_16x16x32_bf16 v[44:47], v[64:67], v[140:143], v[44:47]
    v_mfma_f32_16x16x32_bf16 v[48:51], v[64:67], v[144:147], v[48:51]
    ds_read_b128 v[168:171], v15 offset:1280
    v_mfma_f32_16x16x32_bf16 v[52:55], v[64:67], v[148:151], v[52:55]
    v_mfma_f32_16x16x32_bf16 v[56:59], v[64:67], v[152:155], v[56:59]
    ds_read_b128 v[172:175], v15 offset:1792
    v_mfma_f32_16x16x32_bf16 v[60:63], v[64:67], v[156:159], v[60:63]
    v_mfma_f32_16x16x32_bf16 v[36:39], v[68:71], v[128:131], v[36:39]
    ds_read_b128 v[176:179], v15 offset:2304
    v_mfma_f32_16x16x32_bf16 v[40:43], v[68:71], v[132:135], v[40:43]
    v_mfma_f32_16x16x32_bf16 v[44:47], v[68:71], v[136:139], v[44:47]
    ds_read_b128 v[180:183], v15 offset:2816
    v_mfma_f32_16x16x32_bf16 v[48:51], v[68:71], v[140:143], v[48:51]
    v_mfma_f32_16x16x32_bf16 v[52:55], v[68:71], v[144:147], v[52:55]
    ds_read_b128 v[184:187], v15 offset:3328
    v_mfma_f32_16x16x32_bf16 v[56:59], v[68:71], v[148:151], v[56:59]
    v_mfma_f32_16x16x32_bf16 v[60:63], v[68:71], v[152:155], v[60:63]
    ds_read_b128 v[188:191], v15 offset:3840
    v_mfma_f32_16x16x32_bf16 v[40:43], v[72:75], v[128:131], v[40:43]
    v_mfma_f32_16x16x32_bf16 v[44:47], v[72:75], v[132:135], v[44:47]
    ds_read_b64 v[96:97], v10 offset:192
    ds_read_b64 v[98:99], v10 offset:200
    v_mfma_f32_16x16x32_bf16 v[48:51], v[72:75], v[136:139], v[48:51]
    v_mfma_f32_16x16x32_bf16 v[52:55], v[72:75], v[140:143], v[52:55]
    ds_read_b64 v[100:101], v10 offset:704
    ds_read_b64 v[102:103], v10 offset:712
    v_mfma_f32_16x16x32_bf16 v[56:59], v[72:75], v[144:147], v[56:59]
    v_mfma_f32_16x16x32_bf16 v[60:63], v[72:75], v[148:151], v[60:63]
    ds_read_b64 v[104:105], v10 offset:1216
    ds_read_b64 v[106:107], v10 offset:1224
    v_mfma_f32_16x16x32_bf16 v[44:47], v[76:79], v[128:131], v[44:47]
    v_mfma_f32_16x16x32_bf16 v[48:51], v[76:79], v[132:135], v[48:51]
    ds_read_b64 v[108:109], v10 offset:1728
    ds_read_b64 v[110:111], v10 offset:1736
    v_mfma_f32_16x16x32_bf16 v[52:55], v[76:79], v[136:139], v[52:55]
    v_mfma_f32_16x16x32_bf16 v[56:59], v[76:79], v[140:143], v[56:59]
    ds_read_b64 v[112:113], v10 offset:2240
    ds_read_b64 v[114:115], v10 offset:2248
    v_mfma_f32_16x16x32_bf16 v[60:63], v[76:79], v[144:147], v[60:63]
    v_mfma_f32_16x16x32_bf16 v[48:51], v[80:83], v[128:131], v[48:51]
    ds_read_b64 v[116:117], v10 offset:2752
    ds_read_b64 v[118:119], v10 offset:2760
    v_mfma_f32_16x16x32_bf16 v[52:55], v[80:83], v[132:135], v[52:55]
    v_mfma_f32_16x16x32_bf16 v[56:59], v[80:83], v[136:139], v[56:59]
    ds_read_b64 v[120:121], v10 offset:3264
    ds_read_b64 v[122:123], v10 offset:3272
    v_mfma_f32_16x16x32_bf16 v[60:63], v[80:83], v[140:143], v[60:63]
    v_mfma_f32_16x16x32_bf16 v[52:55], v[84:87], v[128:131], v[52:55]
    ds_read_b64 v[124:125], v10 offset:3776
    ds_read_b64 v[126:127], v10 offset:3784
    v_mfma_f32_16x16x32_bf16 v[56:59], v[84:87], v[132:135], v[56:59]
    v_mfma_f32_16x16x32_bf16 v[60:63], v[84:87], v[136:139], v[60:63]
    v_mfma_f32_16x16x32_bf16 v[56:59], v[88:91], v[128:131], v[56:59]
    ds_read_b32 v31, v30
    v_mfma_f32_16x16x32_bf16 v[60:63], v[88:91], v[132:135], v[60:63]
    v_mfma_f32_16x16x32_bf16 v[60:63], v[92:95], v[128:131], v[60:63]
    s_waitcnt lgkmcnt(0)
    v_readfirstlane_b32 s56, v31
    s_nop 0
    s_cmp_lt_u32 s56, 52
    s_cbranch_scc1 NOY_51
    v_mov_b32 v5, 162084
    s_mov_b32 s70, 0
LW_52:
    s_nop 4
    ds_read_b32 v6, v5
    s_add_u32 s70, s70, 1
    s_waitcnt lgkmcnt(0)
    v_readfirstlane_b32 s71, v6
    s_cmp_gt_u32 s70, 262144
    s_cbranch_scc1 LWX_53
    s_cmp_ge_u32 s71, 4
    s_cbranch_scc1 LWX_53
    s_sleep 8
    s_branch LW_52
LWX_53:
    s_nop 4
NOY_51:
    s_nop 4
    v_mfma_f32_16x16x32_bf16 v[32:35], v[96:99], v[160:163], v[32:35]
    ds_read_b128 v[128:131], v15 offset:192
    v_mfma_f32_16x16x32_bf16 v[36:39], v[96:99], v[164:167], v[36:39]
    v_mfma_f32_16x16x32_bf16 v[40:43], v[96:99], v[168:171], v[40:43]
    ds_read_b128 v[132:135], v15 offset:704
    v_mfma_f32_16x16x32_bf16 v[44:47], v[96:99], v[172:175], v[44:47]
    v_mfma_f32_16x16x32_bf16 v[48:51], v[96:99], v[176:179], v[48:51]
    ds_read_b128 v[136:139], v15 offset:1216
    v_mfma_f32_16x16x32_bf16 v[52:55], v[96:99], v[180:183], v[52:55]
    v_mfma_f32_16x16x32_bf16 v[56:59], v[96:99], v[184:187], v[56:59]
    ds_read_b128 v[140:143], v15 offset:1728
    v_mfma_f32_16x16x32_bf16 v[60:63], v[96:99], v[188:191], v[60:63]
    v_mfma_f32_16x16x32_bf16 v[36:39], v[100:103], v[160:163], v[36:39]
    ds_read_b128 v[144:147], v15 offset:2240
    v_mfma_f32_16x16x32_bf16 v[40:43], v[100:103], v[164:167], v[40:43]
    v_mfma_f32_16x16x32_bf16 v[44:47], v[100:103], v[168:171], v[44:47]
    ds_read_b128 v[148:151], v15 offset:2752
    v_mfma_f32_16x16x32_bf16 v[48:51], v[100:103], v[172:175], v[48:51]
    v_mfma_f32_16x16x32_bf16 v[52:55], v[100:103], v[176:179], v[52:55]
    ds_read_b128 v[152:155], v15 offset:3264
    v_mfma_f32_16x16x32_bf16 v[56:59], v[100:103], v[180:183], v[56:59]
    v_mfma_f32_16x16x32_bf16 v[60:63], v[100:103], v[184:187], v[60:63]
    ds_read_b128 v[156:159], v15 offset:3776
    v_mfma_f32_16x16x32_bf16 v[40:43], v[104:107], v[160:163], v[40:43]
    v_mfma_f32_16x16x32_bf16 v[44:47], v[104:107], v[164:167], v[44:47]
    ds_read_b64 v[64:65], v10 offset:256
    ds_read_b64 v[66:67], v10 offset:264
    v_mfma_f32_16x16x32_bf16 v[48:51], v[104:107], v[168:171], v[48:51]
    v_mfma_f32_16x16x32_bf16 v[52:55], v[104:107], v[172:175], v[52:55]
    ds_read_b64 v[68:69], v10 offset:768
    ds_read_b64 v[70:71], v10 offset:776
    v_mfma_f32_16x16x32_bf16 v[56:59], v[104:107], v[176:179], v[56:59]
    v_mfma_f32_16x16x32_bf16 v[60:63], v[104:107], v[180:183], v[60:63]
    ds_read_b64 v[72:73], v10 offset:1280
    ds_read_b64 v[74:75], v10 offset:1288
    v_mfma_f32_16x16x32_bf16 v[44:47], v[108:111], v[160:163], v[44:47]
    v_mfma_f32_16x16x32_bf16 v[48:51], v[108:111], v[164:167], v[48:51]
    ds_read_b64 v[76:77], v10 offset:1792
    ds_read_b64 v[78:79], v10 offset:1800
    v_mfma_f32_16x16x32_bf16 v[52:55], v[108:111], v[168:171], v[52:55]
    v_mfma_f32_16x16x32_bf16 v[56:59], v[108:111], v[172:175], v[56:59]
    ds_read_b64 v[80:81], v10 offset:2304
    ds_read_b64 v[82:83], v10 offset:2312
    v_mfma_f32_16x16x32_bf16 v[60:63], v[108:111], v[176:179], v[60:63]
    v_mfma_f32_16x16x32_bf16 v[48:51], v[112:115], v[160:163], v[48:51]
    ds_read_b64 v[84:85], v10 offset:2816
    ds_read_b64 v[86:87], v10 offset:2824
    v_mfma_f32_16x16x32_bf16 v[52:55], v[112:115], v[164:167], v[52:55]
    v_mfma_f32_16x16x32_bf16 v[56:59], v[112:115], v[168:171], v[56:59]
    ds_read_b64 v[88:89], v10 offset:3328
    ds_read_b64 v[90:91], v10 offset:3336
    v_mfma_f32_16x16x32_bf16 v[60:63], v[112:115], v[172:175], v[60:63]
    v_mfma_f32_16x16x32_bf16 v[52:55], v[116:119], v[160:163], v[52:55]
    ds_read_b64 v[92:93], v10 offset:3840
    ds_read_b64 v[94:95], v10 offset:3848
    v_mfma_f32_16x16x32_bf16 v[56:59], v[116:119], v[164:167], v[56:59]
    v_mfma_f32_16x16x32_bf16 v[60:63], v[116:119], v[168:171], v[60:63]
    v_mfma_f32_16x16x32_bf16 v[56:59], v[120:123], v[160:163], v[56:59]
    ds_read_b32 v31, v30
    v_mfma_f32_16x16x32_bf16 v[60:63], v[120:123], v[164:167], v[60:63]
    v_mfma_f32_16x16x32_bf16 v[60:63], v[124:127], v[160:163], v[60:63]
    s_waitcnt lgkmcnt(0)
    v_readfirstlane_b32 s56, v31
    s_nop 0
    s_cmp_lt_u32 s56, 52
    s_cbranch_scc1 NOY_54
    v_mov_b32 v5, 162084
    s_mov_b32 s70, 0
LW_55:
    s_nop 4
    ds_read_b32 v6, v5
    s_add_u32 s70, s70, 1
    s_waitcnt lgkmcnt(0)
    v_readfirstlane_b32 s71, v6
    s_cmp_gt_u32 s70, 262144
    s_cbranch_scc1 LWX_56
    s_cmp_ge_u32 s71, 4
    s_cbranch_scc1 LWX_56
    s_sleep 8
    s_branch LW_55
LWX_56:
    s_nop 4
NOY_54:
    s_nop 4
    v_mfma_f32_16x16x32_bf16 v[32:35], v[64:67], v[128:131], v[32:35]
    ds_read_b128 v[160:163], v15 offset:128
    v_mfma_f32_16x16x32_bf16 v[36:39], v[64:67], v[132:135], v[36:39]
    v_mfma_f32_16x16x32_bf16 v[40:43], v[64:67], v[136:139], v[40:43]
    ds_read_b128 v[164:167], v15 offset:640
    v_mfma_f32_16x16x32_bf16 v[44:47], v[64:67], v[140:143], v[44:47]
    v_mfma_f32_16x16x32_bf16 v[48:51], v[64:67], v[144:147], v[48:51]
    ds_read_b128 v[168:171], v15 offset:1152
    v_mfma_f32_16x16x32_bf16 v[52:55], v[64:67], v[148:151], v[52:55]
    v_mfma_f32_16x16x32_bf16 v[56:59], v[64:67], v[152:155], v[56:59]
    ds_read_b128 v[172:175], v15 offset:1664
    v_mfma_f32_16x16x32_bf16 v[60:63], v[64:67], v[156:159], v[60:63]
    v_mfma_f32_16x16x32_bf16 v[36:39], v[68:71], v[128:131], v[36:39]
    ds_read_b128 v[176:179], v15 offset:2176
    v_mfma_f32_16x16x32_bf16 v[40:43], v[68:71], v[132:135], v[40:43]
    v_mfma_f32_16x16x32_bf16 v[44:47], v[68:71], v[136:139], v[44:47]
    ds_read_b128 v[180:183], v15 offset:2688
    v_mfma_f32_16x16x32_bf16 v[48:51], v[68:71], v[140:143], v[48:51]
    v_mfma_f32_16x16x32_bf16 v[52:55], v[68:71], v[144:147], v[52:55]
    ds_read_b128 v[184:187], v15 offset:3200
    v_mfma_f32_16x16x32_bf16 v[56:59], v[68:71], v[148:151], v[56:59]
    v_mfma_f32_16x16x32_bf16 v[60:63], v[68:71], v[152:155], v[60:63]
    ds_read_b128 v[188:191], v15 offset:3712
    v_mfma_f32_16x16x32_bf16 v[40:43], v[72:75], v[128:131], v[40:43]
    v_mfma_f32_16x16x32_bf16 v[44:47], v[72:75], v[132:135], v[44:47]
    ds_read_b64 v[96:97], v10 offset:320
    ds_read_b64 v[98:99], v10 offset:328
    v_mfma_f32_16x16x32_bf16 v[48:51], v[72:75], v[136:139], v[48:51]
    v_mfma_f32_16x16x32_bf16 v[52:55], v[72:75], v[140:143], v[52:55]
    ds_read_b64 v[100:101], v10 offset:832
    ds_read_b64 v[102:103], v10 offset:840
    v_mfma_f32_16x16x32_bf16 v[56:59], v[72:75], v[144:147], v[56:59]
    v_mfma_f32_16x16x32_bf16 v[60:63], v[72:75], v[148:151], v[60:63]
    ds_read_b64 v[104:105], v10 offset:1344
    ds_read_b64 v[106:107], v10 offset:1352
    v_mfma_f32_16x16x32_bf16 v[44:47], v[76:79], v[128:131], v[44:47]
    v_mfma_f32_16x16x32_bf16 v[48:51], v[76:79], v[132:135], v[48:51]
    ds_read_b64 v[108:109], v10 offset:1856
    ds_read_b64 v[110:111], v10 offset:1864
    v_mfma_f32_16x16x32_bf16 v[52:55], v[76:79], v[136:139], v[52:55]
    v_mfma_f32_16x16x32_bf16 v[56:59], v[76:79], v[140:143], v[56:59]
    ds_read_b64 v[112:113], v10 offset:2368
    ds_read_b64 v[114:115], v10 offset:2376
    v_mfma_f32_16x16x32_bf16 v[60:63], v[76:79], v[144:147], v[60:63]
    v_mfma_f32_16x16x32_bf16 v[48:51], v[80:83], v[128:131], v[48:51]
    ds_read_b64 v[116:117], v10 offset:2880
    ds_read_b64 v[118:119], v10 offset:2888
    v_mfma_f32_16x16x32_bf16 v[52:55], v[80:83], v[132:135], v[52:55]
    v_mfma_f32_16x16x32_bf16 v[56:59], v[80:83], v[136:139], v[56:59]
    ds_read_b64 v[120:121], v10 offset:3392
    ds_read_b64 v[122:123], v10 offset:3400
    v_mfma_f32_16x16x32_bf16 v[60:63], v[80:83], v[140:143], v[60:63]
    v_mfma_f32_16x16x32_bf16 v[52:55], v[84:87], v[128:131], v[52:55]
    ds_read_b64 v[124:125], v10 offset:3904
    ds_read_b64 v[126:127], v10 offset:3912
    v_mfma_f32_16x16x32_bf16 v[56:59], v[84:87], v[132:135], v[56:59]
    v_mfma_f32_16x16x32_bf16 v[60:63], v[84:87], v[136:139], v[60:63]
    v_mfma_f32_16x16x32_bf16 v[56:59], v[88:91], v[128:131], v[56:59]
    ds_read_b32 v31, v30
    v_mfma_f32_16x16x32_bf16 v[60:63], v[88:91], v[132:135], v[60:63]
    v_mfma_f32_16x16x32_bf16 v[60:63], v[92:95], v[128:131], v[60:63]
    s_waitcnt lgkmcnt(0)
    v_readfirstlane_b32 s56, v31
    s_nop 0
    s_cmp_lt_u32 s56, 52
    s_cbranch_scc1 NOY_57
    v_mov_b32 v5, 162084
    s_mov_b32 s70, 0
LW_58:
    s_nop 4
    ds_read_b32 v6, v5
    s_add_u32 s70, s70, 1
    s_waitcnt lgkmcnt(0)
    v_readfirstlane_b32 s71, v6
    s_cmp_gt_u32 s70, 262144
    s_cbranch_scc1 LWX_59
    s_cmp_ge_u32 s71, 4
    s_cbranch_scc1 LWX_59
    s_sleep 8
    s_branch LW_58
LWX_59:
    s_nop 4
NOY_57:
    s_nop 4
    v_mfma_f32_16x16x32_bf16 v[32:35], v[96:99], v[160:163], v[32:35]
    ds_read_b128 v[128:131], v15 offset:64
    v_mfma_f32_16x16x32_bf16 v[36:39], v[96:99], v[164:167], v[36:39]
    v_mfma_f32_16x16x32_bf16 v[40:43], v[96:99], v[168:171], v[40:43]
    ds_read_b128 v[132:135], v15 offset:576
    v_mfma_f32_16x16x32_bf16 v[44:47], v[96:99], v[172:175], v[44:47]
    v_mfma_f32_16x16x32_bf16 v[48:51], v[96:99], v[176:179], v[48:51]
    ds_read_b128 v[136:139], v15 offset:1088
    v_mfma_f32_16x16x32_bf16 v[52:55], v[96:99], v[180:183], v[52:55]
    v_mfma_f32_16x16x32_bf16 v[56:59], v[96:99], v[184:187], v[56:59]
    ds_read_b128 v[140:143], v15 offset:1600
    v_mfma_f32_16x16x32_bf16 v[60:63], v[96:99], v[188:191], v[60:63]
    v_mfma_f32_16x16x32_bf16 v[36:39], v[100:103], v[160:163], v[36:39]
    ds_read_b128 v[144:147], v15 offset:2112
    v_mfma_f32_16x16x32_bf16 v[40:43], v[100:103], v[164:167], v[40:43]
    v_mfma_f32_16x16x32_bf16 v[44:47], v[100:103], v[168:171], v[44:47]
    ds_read_b128 v[148:151], v15 offset:2624
    v_mfma_f32_16x16x32_bf16 v[48:51], v[100:103], v[172:175], v[48:51]
    v_mfma_f32_16x16x32_bf16 v[52:55], v[100:103], v[176:179], v[52:55]
    ds_read_b128 v[152:155], v15 offset:3136
    v_mfma_f32_16x16x32_bf16 v[56:59], v[100:103], v[180:183], v[56:59]
    v_mfma_f32_16x16x32_bf16 v[60:63], v[100:103], v[184:187], v[60:63]
    ds_read_b128 v[156:159], v15 offset:3648
    v_mfma_f32_16x16x32_bf16 v[40:43], v[104:107], v[160:163], v[40:43]
    v_mfma_f32_16x16x32_bf16 v[44:47], v[104:107], v[164:167], v[44:47]
    ds_read_b64 v[64:65], v10 offset:384
    ds_read_b64 v[66:67], v10 offset:392
    v_mfma_f32_16x16x32_bf16 v[48:51], v[104:107], v[168:171], v[48:51]
    v_mfma_f32_16x16x32_bf16 v[52:55], v[104:107], v[172:175], v[52:55]
    ds_read_b64 v[68:69], v10 offset:896
    ds_read_b64 v[70:71], v10 offset:904
    v_mfma_f32_16x16x32_bf16 v[56:59], v[104:107], v[176:179], v[56:59]
    v_mfma_f32_16x16x32_bf16 v[60:63], v[104:107], v[180:183], v[60:63]
    ds_read_b64 v[72:73], v10 offset:1408
    ds_read_b64 v[74:75], v10 offset:1416
    v_mfma_f32_16x16x32_bf16 v[44:47], v[108:111], v[160:163], v[44:47]
    v_mfma_f32_16x16x32_bf16 v[48:51], v[108:111], v[164:167], v[48:51]
    ds_read_b64 v[76:77], v10 offset:1920
    ds_read_b64 v[78:79], v10 offset:1928
    v_mfma_f32_16x16x32_bf16 v[52:55], v[108:111], v[168:171], v[52:55]
    v_mfma_f32_16x16x32_bf16 v[56:59], v[108:111], v[172:175], v[56:59]
    ds_read_b64 v[80:81], v10 offset:2432
    ds_read_b64 v[82:83], v10 offset:2440
    v_mfma_f32_16x16x32_bf16 v[60:63], v[108:111], v[176:179], v[60:63]
    v_mfma_f32_16x16x32_bf16 v[48:51], v[112:115], v[160:163], v[48:51]
    ds_read_b64 v[84:85], v10 offset:2944
    ds_read_b64 v[86:87], v10 offset:2952
    v_mfma_f32_16x16x32_bf16 v[52:55], v[112:115], v[164:167], v[52:55]
    v_mfma_f32_16x16x32_bf16 v[56:59], v[112:115], v[168:171], v[56:59]
    ds_read_b64 v[88:89], v10 offset:3456
    ds_read_b64 v[90:91], v10 offset:3464
    v_mfma_f32_16x16x32_bf16 v[60:63], v[112:115], v[172:175], v[60:63]
    v_mfma_f32_16x16x32_bf16 v[52:55], v[116:119], v[160:163], v[52:55]
    ds_read_b64 v[92:93], v10 offset:3968
    ds_read_b64 v[94:95], v10 offset:3976
    v_mfma_f32_16x16x32_bf16 v[56:59], v[116:119], v[164:167], v[56:59]
    v_mfma_f32_16x16x32_bf16 v[60:63], v[116:119], v[168:171], v[60:63]
    v_mfma_f32_16x16x32_bf16 v[56:59], v[120:123], v[160:163], v[56:59]
    ds_read_b32 v31, v30
    v_mfma_f32_16x16x32_bf16 v[60:63], v[120:123], v[164:167], v[60:63]
    v_mfma_f32_16x16x32_bf16 v[60:63], v[124:127], v[160:163], v[60:63]
    s_waitcnt lgkmcnt(0)
    v_readfirstlane_b32 s56, v31
    s_nop 0
    s_cmp_lt_u32 s56, 52
    s_cbranch_scc1 NOY_60
    v_mov_b32 v5, 162084
    s_mov_b32 s70, 0
LW_61:
    s_nop 4
    ds_read_b32 v6, v5
    s_add_u32 s70, s70, 1
    s_waitcnt lgkmcnt(0)
    v_readfirstlane_b32 s71, v6
    s_cmp_gt_u32 s70, 262144
    s_cbranch_scc1 LWX_62
    s_cmp_ge_u32 s71, 4
    s_cbranch_scc1 LWX_62
    s_sleep 8
    s_branch LW_61
LWX_62:
    s_nop 4
NOY_60:
    s_nop 4
    v_mfma_f32_16x16x32_bf16 v[32:35], v[64:67], v[128:131], v[32:35]
    ds_read_b128 v[160:163], v15 offset:0
    v_mfma_f32_16x16x32_bf16 v[36:39], v[64:67], v[132:135], v[36:39]
    v_mfma_f32_16x16x32_bf16 v[40:43], v[64:67], v[136:139], v[40:43]
    ds_read_b128 v[164:167], v15 offset:512
    v_mfma_f32_16x16x32_bf16 v[44:47], v[64:67], v[140:143], v[44:47]
    v_mfma_f32_16x16x32_bf16 v[48:51], v[64:67], v[144:147], v[48:51]
    ds_read_b128 v[168:171], v15 offset:1024
    v_mfma_f32_16x16x32_bf16 v[52:55], v[64:67], v[148:151], v[52:55]
    v_mfma_f32_16x16x32_bf16 v[56:59], v[64:67], v[152:155], v[56:59]
    ds_read_b128 v[172:175], v15 offset:1536
    v_mfma_f32_16x16x32_bf16 v[60:63], v[64:67], v[156:159], v[60:63]
    v_mfma_f32_16x16x32_bf16 v[36:39], v[68:71], v[128:131], v[36:39]
    ds_read_b128 v[176:179], v15 offset:2048
    v_mfma_f32_16x16x32_bf16 v[40:43], v[68:71], v[132:135], v[40:43]
    v_mfma_f32_16x16x32_bf16 v[44:47], v[68:71], v[136:139], v[44:47]
    ds_read_b128 v[180:183], v15 offset:2560
    v_mfma_f32_16x16x32_bf16 v[48:51], v[68:71], v[140:143], v[48:51]
    v_mfma_f32_16x16x32_bf16 v[52:55], v[68:71], v[144:147], v[52:55]
    ds_read_b128 v[184:187], v15 offset:3072
    v_mfma_f32_16x16x32_bf16 v[56:59], v[68:71], v[148:151], v[56:59]
    v_mfma_f32_16x16x32_bf16 v[60:63], v[68:71], v[152:155], v[60:63]
    ds_read_b128 v[188:191], v15 offset:3584
    v_mfma_f32_16x16x32_bf16 v[40:43], v[72:75], v[128:131], v[40:43]
    v_mfma_f32_16x16x32_bf16 v[44:47], v[72:75], v[132:135], v[44:47]
    ds_read_b64 v[96:97], v10 offset:448
    ds_read_b64 v[98:99], v10 offset:456
    v_mfma_f32_16x16x32_bf16 v[48:51], v[72:75], v[136:139], v[48:51]
    v_mfma_f32_16x16x32_bf16 v[52:55], v[72:75], v[140:143], v[52:55]
    ds_read_b64 v[100:101], v10 offset:960
    ds_read_b64 v[102:103], v10 offset:968
    v_mfma_f32_16x16x32_bf16 v[56:59], v[72:75], v[144:147], v[56:59]
    v_mfma_f32_16x16x32_bf16 v[60:63], v[72:75], v[148:151], v[60:63]
    ds_read_b64 v[104:105], v10 offset:1472
    ds_read_b64 v[106:107], v10 offset:1480
    v_mfma_f32_16x16x32_bf16 v[44:47], v[76:79], v[128:131], v[44:47]
    v_mfma_f32_16x16x32_bf16 v[48:51], v[76:79], v[132:135], v[48:51]
    ds_read_b64 v[108:109], v10 offset:1984
    ds_read_b64 v[110:111], v10 offset:1992
    v_mfma_f32_16x16x32_bf16 v[52:55], v[76:79], v[136:139], v[52:55]
    v_mfma_f32_16x16x32_bf16 v[56:59], v[76:79], v[140:143], v[56:59]
    ds_read_b64 v[112:113], v10 offset:2496
    ds_read_b64 v[114:115], v10 offset:2504
    v_mfma_f32_16x16x32_bf16 v[60:63], v[76:79], v[144:147], v[60:63]
    v_mfma_f32_16x16x32_bf16 v[48:51], v[80:83], v[128:131], v[48:51]
    ds_read_b64 v[116:117], v10 offset:3008
    ds_read_b64 v[118:119], v10 offset:3016
    v_mfma_f32_16x16x32_bf16 v[52:55], v[80:83], v[132:135], v[52:55]
    v_mfma_f32_16x16x32_bf16 v[56:59], v[80:83], v[136:139], v[56:59]
    ds_read_b64 v[120:121], v10 offset:3520
    ds_read_b64 v[122:123], v10 offset:3528
    v_mfma_f32_16x16x32_bf16 v[60:63], v[80:83], v[140:143], v[60:63]
    v_mfma_f32_16x16x32_bf16 v[52:55], v[84:87], v[128:131], v[52:55]
    ds_read_b64 v[124:125], v10 offset:4032
    ds_read_b64 v[126:127], v10 offset:4040
    v_mfma_f32_16x16x32_bf16 v[56:59], v[84:87], v[132:135], v[56:59]
    v_mfma_f32_16x16x32_bf16 v[60:63], v[84:87], v[136:139], v[60:63]
    v_mfma_f32_16x16x32_bf16 v[56:59], v[88:91], v[128:131], v[56:59]
    ds_read_b32 v31, v30
    v_mfma_f32_16x16x32_bf16 v[60:63], v[88:91], v[132:135], v[60:63]
    v_mfma_f32_16x16x32_bf16 v[60:63], v[92:95], v[128:131], v[60:63]
    s_waitcnt lgkmcnt(0)
    v_readfirstlane_b32 s56, v31
    s_nop 0
    s_cmp_lt_u32 s56, 52
    s_cbranch_scc1 NOY_63
    v_mov_b32 v5, 162084
    s_mov_b32 s70, 0
LW_64:
    s_nop 4
    ds_read_b32 v6, v5
    s_add_u32 s70, s70, 1
    s_waitcnt lgkmcnt(0)
    v_readfirstlane_b32 s71, v6
    s_cmp_gt_u32 s70, 262144
    s_cbranch_scc1 LWX_65
    s_cmp_ge_u32 s71, 4
    s_cbranch_scc1 LWX_65
    s_sleep 8
    s_branch LW_64
LWX_65:
    s_nop 4
NOY_63:
    s_nop 4
    v_mfma_f32_16x16x32_bf16 v[32:35], v[96:99], v[160:163], v[32:35]
    v_mfma_f32_16x16x32_bf16 v[36:39], v[96:99], v[164:167], v[36:39]
    v_mfma_f32_16x16x32_bf16 v[40:43], v[96:99], v[168:171], v[40:43]
    v_mfma_f32_16x16x32_bf16 v[44:47], v[96:99], v[172:175], v[44:47]
    v_mfma_f32_16x16x32_bf16 v[48:51], v[96:99], v[176:179], v[48:51]
    v_mfma_f32_16x16x32_bf16 v[52:55], v[96:99], v[180:183], v[52:55]
    v_mfma_f32_16x16x32_bf16 v[56:59], v[96:99], v[184:187], v[56:59]
    v_mfma_f32_16x16x32_bf16 v[60:63], v[96:99], v[188:191], v[60:63]
    v_mfma_f32_16x16x32_bf16 v[36:39], v[100:103], v[160:163], v[36:39]
    v_mfma_f32_16x16x32_bf16 v[40:43], v[100:103], v[164:167], v[40:43]
    v_mfma_f32_16x16x32_bf16 v[44:47], v[100:103], v[168:171], v[44:47]
    v_mfma_f32_16x16x32_bf16 v[48:51], v[100:103], v[172:175], v[48:51]
    v_mfma_f32_16x16x32_bf16 v[52:55], v[100:103], v[176:179], v[52:55]
    v_mfma_f32_16x16x32_bf16 v[56:59], v[100:103], v[180:183], v[56:59]
    v_mfma_f32_16x16x32_bf16 v[60:63], v[100:103], v[184:187], v[60:63]
    v_mfma_f32_16x16x32_bf16 v[40:43], v[104:107], v[160:163], v[40:43]
    v_mfma_f32_16x16x32_bf16 v[44:47], v[104:107], v[164:167], v[44:47]
    v_mfma_f32_16x16x32_bf16 v[48:51], v[104:107], v[168:171], v[48:51]
    v_mfma_f32_16x16x32_bf16 v[52:55], v[104:107], v[172:175], v[52:55]
    v_mfma_f32_16x16x32_bf16 v[56:59], v[104:107], v[176:179], v[56:59]
    v_mfma_f32_16x16x32_bf16 v[60:63], v[104:107], v[180:183], v[60:63]
    v_mfma_f32_16x16x32_bf16 v[44:47], v[108:111], v[160:163], v[44:47]
    v_mfma_f32_16x16x32_bf16 v[48:51], v[108:111], v[164:167], v[48:51]
    v_mfma_f32_16x16x32_bf16 v[52:55], v[108:111], v[168:171], v[52:55]
    v_mfma_f32_16x16x32_bf16 v[56:59], v[108:111], v[172:175], v[56:59]
    v_mfma_f32_16x16x32_bf16 v[60:63], v[108:111], v[176:179], v[60:63]
    v_mfma_f32_16x16x32_bf16 v[48:51], v[112:115], v[160:163], v[48:51]
    v_mfma_f32_16x16x32_bf16 v[52:55], v[112:115], v[164:167], v[52:55]
    v_mfma_f32_16x16x32_bf16 v[56:59], v[112:115], v[168:171], v[56:59]
    v_mfma_f32_16x16x32_bf16 v[60:63], v[112:115], v[172:175], v[60:63]
    v_mfma_f32_16x16x32_bf16 v[52:55], v[116:119], v[160:163], v[52:55]
    v_mfma_f32_16x16x32_bf16 v[56:59], v[116:119], v[164:167], v[56:59]
    v_mfma_f32_16x16x32_bf16 v[60:63], v[116:119], v[168:171], v[60:63]
    v_mfma_f32_16x16x32_bf16 v[56:59], v[120:123], v[160:163], v[56:59]
    v_mfma_f32_16x16x32_bf16 v[60:63], v[120:123], v[164:167], v[60:63]
    v_mfma_f32_16x16x32_bf16 v[60:63], v[124:127], v[160:163], v[60:63]
    s_setprio 3
    s_add_u32 s57, s62, 5439488
    v_and_b32 v13, 1, v12
    v_lshlrev_b32 v22, 9, v13
    v_lshl_add_u32 v22, v11, 5, v22
    v_lshrrev_b32 v13, 1, v12
    v_lshl_add_u32 v22, v13, 4, v22
    v_cvt_pk_bf16_f32 v64, v32, v33
    v_cvt_pk_bf16_f32 v65, v34, v35
    v_cvt_pk_bf16_f32 v66, v36, v37
    v_cvt_pk_bf16_f32 v67, v38, v39
    s_nop 0
    v_permlane16_swap_b32 v64, v66
    v_permlane16_swap_b32 v65, v67
    buffer_store_dwordx4 v[64:67], v22, s[32:35], s57 offen offset:0 sc1
    v_cvt_pk_bf16_f32 v68, v40, v41
    v_cvt_pk_bf16_f32 v69, v42, v43
    v_cvt_pk_bf16_f32 v70, v44, v45
    v_cvt_pk_bf16_f32 v71, v46, v47
    s_nop 0
    v_permlane16_swap_b32 v68, v70
    v_permlane16_swap_b32 v69, v71
    buffer_store_dwordx4 v[68:71], v22, s[32:35], s57 offen offset:1024 sc1
    v_cvt_pk_bf16_f32 v72, v48, v49
    v_cvt_pk_bf16_f32 v73, v50, v51
    v_cvt_pk_bf16_f32 v74, v52, v53
    v_cvt_pk_bf16_f32 v75, v54, v55
    s_nop 0
    v_permlane16_swap_b32 v72, v74
    v_permlane16_swap_b32 v73, v75
    buffer_store_dwordx4 v[72:75], v22, s[32:35], s57 offen offset:2048 sc1
    v_cvt_pk_bf16_f32 v76, v56, v57
    v_cvt_pk_bf16_f32 v77, v58, v59
    v_cvt_pk_bf16_f32 v78, v60, v61
    v_cvt_pk_bf16_f32 v79, v62, v63
    s_nop 0
    v_permlane16_swap_b32 v76, v78
    v_permlane16_swap_b32 v77, v79
    buffer_store_dwordx4 v[76:79], v22, s[32:35], s57 offen offset:3072 sc1
    v_mov_b32 v190, v232
    v_mov_b32 v191, v233
    s_add_u32 s58, s43, 512
    s_lshr_b32 s56, s2, 3
    s_lshr_b32 s65, s56, 2
    s_and_b32 s66, s56, 3
    s_and_b32 s56, s2, 7
    s_lshl_b32 s56, s56, 2
    s_add_u32 s66, s66, s56
    s_lshl_b32 s68, s66, 6
    s_lshl_b32 s56, s64, 4
    s_add_u32 s68, s68, s56
    s_mul_i32 s67, s64, 24576
    s_mov_b32 s63, s58
    s_mul_i32 s69, s68, 1280
    s_mul_i32 s56, s65, 160
    s_add_u32 s69, s69, s56
    s_mov_b32 s48, s4
    s_and_b32 s49, s5, 0xffff
    s_mov_b32 s50, 2621440
    s_mov_b32 s51, 0x00020000
    s_movk_i32 s56, 1280
    v_add_u32 v232, 0, v2
    v_mul_u32_u24 v233, 205, v232
    v_lshrrev_b32 v233, 11, v233
    v_mul_u32_u24 v234, 10, v233
    v_sub_u32 v234, v232, v234
    v_lshlrev_b32 v234, 4, v234
    v_mad_u32_u24 v236, v233, s56, v234
    s_add_u32 m0, s63, 0
    s_nop 0
    buffer_load_dwordx4 v236, s[48:51], s69 offen  lds
    v_add_u32 v232, 64, v2
    v_mul_u32_u24 v233, 205, v232
    v_lshrrev_b32 v233, 11, v233
    v_mul_u32_u24 v234, 10, v233
    v_sub_u32 v234, v232, v234
    v_lshlrev_b32 v234, 4, v234
    v_mad_u32_u24 v236, v233, s56, v234
    s_add_u32 m0, s63, 1024
    s_nop 0
    buffer_load_dwordx4 v236, s[48:51], s69 offen  lds
    v_add_u32 v232, 128, v2
    v_mul_u32_u24 v233, 205, v232
    v_lshrrev_b32 v233, 11, v233
    v_mul_u32_u24 v234, 10, v233
    v_sub_u32 v234, v232, v234
    v_lshlrev_b32 v234, 4, v234
    v_mad_u32_u24 v236, v233, s56, v234
    s_add_u32 m0, s63, 2048
    s_mov_b32 exec_lo, 0xffffffff
    s_mov_b32 exec_hi, 0x0
    buffer_load_dwordx4 v236, s[48:51], s69 offen  lds
    s_mov_b64 exec, -1
    v_and_b32 v232, 15, v2
    s_movk_i32 s56, 160
    v_mul_u32_u24 v240, s56, v232
    v_lshrrev_b32 v233, 4, v2
    v_lshl_add_u32 v240, v233, 3, v240
    v_add_u32 v240, s63, v240
    s_mul_i32 s59, s41, 16
    s_add_u32 s59, s59, 81920
    s_waitcnt vmcnt(3)
    v_mov_b32 v12, s30
    v_mov_b32 v13, s31
    v_mov_b32 v14, 0
    s_mov_b64 exec, 1
    buffer_store_dwordx2 v[12:13], v14, s[32:35], s59 offen sc1
    s_mov_b64 exec, -1
    s_waitcnt vmcnt(0)
    ds_read_b64 v[242:243], v240 offset:0
    ds_read_b64 v[244:245], v240 offset:32
    ds_read_b64 v[246:247], v240 offset:64
    ds_read_b64 v[248:249], v240 offset:96
    ds_read_b64 v[250:251], v240 offset:128
    v_mov_b32 v232, v190
    v_mov_b32 v233, v191
    v_mov_b32 v5, 162084
    s_mov_b32 s70, 0
LW_66:
    s_nop 4
    ds_read_b32 v6, v5
    s_add_u32 s70, s70, 1
    s_waitcnt lgkmcnt(0)
    v_readfirstlane_b32 s71, v6
    s_cmp_gt_u32 s70, 262144
    s_cbranch_scc1 LWX_67
    s_cmp_ge_u32 s71, 4
    s_cbranch_scc1 LWX_67
    s_sleep 8
    s_branch LW_66
LWX_67:
    s_nop 4
    v_lshlrev_b32 v192, 16, v242
    v_and_b32 v193, 0xffff0000, v242
    v_lshlrev_b32 v194, 16, v243
    v_and_b32 v195, 0xffff0000, v243
    v_lshlrev_b32 v196, 16, v244
    v_and_b32 v197, 0xffff0000, v244
    v_lshlrev_b32 v198, 16, v245
    v_and_b32 v199, 0xffff0000, v245
    v_lshlrev_b32 v200, 16, v246
    v_and_b32 v201, 0xffff0000, v246
    v_lshlrev_b32 v202, 16, v247
    v_and_b32 v203, 0xffff0000, v247
    v_lshlrev_b32 v204, 16, v248
    v_and_b32 v205, 0xffff0000, v248
    v_lshlrev_b32 v206, 16, v249
    v_and_b32 v207, 0xffff0000, v249
    v_lshlrev_b32 v208, 16, v250
    v_and_b32 v209, 0xffff0000, v250
    v_lshlrev_b32 v210, 16, v251
    v_and_b32 v211, 0xffff0000, v251
    v_sub_f32 v212, v192, v232
    v_sub_f32 v213, v193, v232
    v_sub_f32 v214, v194, v232
    v_sub_f32 v215, v195, v232
    v_sub_f32 v216, v196, v232
    v_sub_f32 v217, v197, v232
    v_sub_f32 v218, v198, v232
    v_sub_f32 v219, v199, v232
    v_sub_f32 v220, v200, v232
    v_sub_f32 v221, v201, v232
    v_sub_f32 v222, v202, v232
    v_sub_f32 v223, v203, v232
    v_sub_f32 v224, v204, v232
    v_sub_f32 v225, v205, v232
    v_sub_f32 v226, v206, v232
    v_sub_f32 v227, v207, v232
    v_sub_f32 v228, v208, v232
    v_sub_f32 v229, v209, v232
    v_sub_f32 v230, v210, v232
    v_sub_f32 v231, v211, v232
    v_cvt_pk_bf16_f32 v242, v212, v213
    v_cvt_pk_bf16_f32 v243, v214, v215
    v_cvt_pk_bf16_f32 v244, v216, v217
    v_cvt_pk_bf16_f32 v245, v218, v219
    v_cvt_pk_bf16_f32 v246, v220, v221
    v_cvt_pk_bf16_f32 v247, v222, v223
    v_cvt_pk_bf16_f32 v248, v224, v225
    v_cvt_pk_bf16_f32 v249, v226, v227
    v_cvt_pk_bf16_f32 v250, v228, v229
    v_cvt_pk_bf16_f32 v251, v230, v231
    v_lshlrev_b32 v212, 16, v242
    v_and_b32 v213, 0xffff0000, v242
    v_lshlrev_b32 v214, 16, v243
    v_and_b32 v215, 0xffff0000, v243
    v_lshlrev_b32 v216, 16, v244
    v_and_b32 v217, 0xffff0000, v244
    v_lshlrev_b32 v218, 16, v245
    v_and_b32 v219, 0xffff0000, v245
    v_lshlrev_b32 v220, 16, v246
    v_and_b32 v221, 0xffff0000, v246
    v_lshlrev_b32 v222, 16, v247
    v_and_b32 v223, 0xffff0000, v247
    v_lshlrev_b32 v224, 16, v248
    v_and_b32 v225, 0xffff0000, v248
    v_lshlrev_b32 v226, 16, v249
    v_and_b32 v227, 0xffff0000, v249
    v_lshlrev_b32 v228, 16, v250
    v_and_b32 v229, 0xffff0000, v250
    v_lshlrev_b32 v230, 16, v251
    v_and_b32 v231, 0xffff0000, v251
    v_mul_f32 v212, v212, v233
    v_mul_f32 v213, v213, v233
    v_mul_f32 v214, v214, v233
    v_mul_f32 v215, v215, v233
    v_mul_f32 v216, v216, v233
    v_mul_f32 v217, v217, v233
    v_mul_f32 v218, v218, v233
    v_mul_f32 v219, v219, v233
    v_mul_f32 v220, v220, v233
    v_mul_f32 v221, v221, v233
    v_mul_f32 v222, v222, v233
    v_mul_f32 v223, v223, v233
    v_mul_f32 v224, v224, v233
    v_mul_f32 v225, v225, v233
    v_mul_f32 v226, v226, v233
    v_mul_f32 v227, v227, v233
    v_mul_f32 v228, v228, v233
    v_mul_f32 v229, v229, v233
    v_mul_f32 v230, v230, v233
    v_mul_f32 v231, v231, v233
    v_cvt_pk_bf16_f32 v242, v212, v213
    v_cvt_pk_bf16_f32 v243, v214, v215
    v_cvt_pk_bf16_f32 v244, v216, v217
    v_cvt_pk_bf16_f32 v245, v218, v219
    v_cvt_pk_bf16_f32 v246, v220, v221
    v_cvt_pk_bf16_f32 v247, v222, v223
    v_cvt_pk_bf16_f32 v248, v224, v225
    v_cvt_pk_bf16_f32 v249, v226, v227
    v_cvt_pk_bf16_f32 v250, v228, v229
    v_cvt_pk_bf16_f32 v251, v230, v231
    v_lshlrev_b32 v212, 16, v242
    v_and_b32 v213, 0xffff0000, v242
    v_lshlrev_b32 v214, 16, v243
    v_and_b32 v215, 0xffff0000, v243
    v_lshlrev_b32 v216, 16, v244
    v_and_b32 v217, 0xffff0000, v244
    v_lshlrev_b32 v218, 16, v245
    v_and_b32 v219, 0xffff0000, v245
    v_lshlrev_b32 v220, 16, v246
    v_and_b32 v221, 0xffff0000, v246
    v_lshlrev_b32 v222, 16, v247
    v_and_b32 v223, 0xffff0000, v247
    v_lshlrev_b32 v224, 16, v248
    v_and_b32 v225, 0xffff0000, v248
    v_lshlrev_b32 v226, 16, v249
    v_and_b32 v227, 0xffff0000, v249
    v_lshlrev_b32 v228, 16, v250
    v_and_b32 v229, 0xffff0000, v250
    v_lshlrev_b32 v230, 16, v251
    v_and_b32 v231, 0xffff0000, v251
    s_branch KF_P2
KF_NOCONV:
    s_nop 4
    s_waitcnt vmcnt(0)
    v_mov_b32 v12, s30
    v_mov_b32 v13, s31
    v_mov_b32 v14, 0
    s_mov_b64 exec, 1
    buffer_store_dwordx2 v[12:13], v14, s[32:35], s59 offen sc1
    s_mov_b64 exec, -1
    v_mov_b32 v5, 162076
    v_mov_b32 v6, 1
    s_waitcnt lgkmcnt(0)
    s_mov_b64 exec, 1
    ds_add_u32 v5, v6
    s_mov_b64 exec, -1
    s_cmp_lg_u32 s64, 3
    s_cbranch_scc1 KF_AUXEND
    s_lshr_b32 s60, s2, 3
    s_and_b32 s61, s2, 7
    s_lshr_b32 s57, s60, 2
    s_and_b32 s56, s60, 3
    s_lshl_b32 s58, s61, 2
    s_add_u32 s56, s56, s58
    s_lshr_b32 s58, s57, 1
    s_mul_i32 s58, s58, 384
    s_and_b32 s57, s57, 1
    s_mul_i32 s57, s57, 128
    s_add_u32 s57, s57, s58
    s_add_u32 s57, s57, 128
    s_lshl_b32 s57, s57, 12
    s_lshl_b32 s56, s56, 7
    s_add_u32 s57, s57, s56
    v_lshrrev_b32 v59, 3, v2
    v_and_b32 v60, 7, v2
    v_lshlrev_b32 v60, 4, v60
    v_lshl_add_u32 v62, v59, 12, v60
    s_mov_b32 s36, s22
    s_and_b32 s37, s23, 0xffff
    s_mov_b32 s38, 6291456
    s_mov_b32 s39, 0x00020000
    s_lshr_b32 s58, s2, 3
    s_and_b32 s58, s58, 7
    s_add_u32 s58, s58, 1
    s_lshl_b32 s58, s58, 2
    v_mov_b32 v5, 162072
    s_mov_b32 s70, 0
LW_68:
    s_nop 4
    ds_read_b32 v6, v5
    s_add_u32 s70, s70, 1
    s_waitcnt lgkmcnt(0)
    v_readfirstlane_b32 s71, v6
    s_cmp_gt_u32 s70, 262144
    s_cbranch_scc1 LWX_69
    s_cmp_ge_u32 s71, s58
    s_cbranch_scc1 LWX_69
    s_sleep 4
    s_branch LW_68
LWX_69:
    s_nop 4
    buffer_load_dwordx4 v[64:67], v62, s[36:39], s57 offen
    s_add_u32 s57, s57, 32768
    buffer_load_dwordx4 v[68:71], v62, s[36:39], s57 offen
    s_add_u32 s57, s57, 32768
    buffer_load_dwordx4 v[72:75], v62, s[36:39], s57 offen
    s_add_u32 s57, s57, 32768
    buffer_load_dwordx4 v[76:79], v62, s[36:39], s57 offen
    s_add_u32 s57, s57, 32768
    buffer_load_dwordx4 v[80:83], v62, s[36:39], s57 offen
    s_add_u32 s57, s57, 32768
    buffer_load_dwordx4 v[84:87], v62, s[36:39], s57 offen
    s_add_u32 s57, s57, 32768
    buffer_load_dwordx4 v[88:91], v62, s[36:39], s57 offen
    s_add_u32 s57, s57, 32768
    buffer_load_dwordx4 v[92:95], v62, s[36:39], s57 offen
    s_add_u32 s57, s57, 32768
    buffer_load_dwordx4 v[96:99], v62, s[36:39], s57 offen
    s_add_u32 s57, s57, 32768
    buffer_load_dwordx4 v[100:103], v62, s[36:39], s57 offen
    s_add_u32 s57, s57, 32768
    buffer_load_dwordx4 v[104:107], v62, s[36:39], s57 offen
    s_add_u32 s57, s57, 32768
    buffer_load_dwordx4 v[108:111], v62, s[36:39], s57 offen
    s_add_u32 s57, s57, 32768
    buffer_load_dwordx4 v[112:115], v62, s[36:39], s57 offen
    s_add_u32 s57, s57, 32768
    buffer_load_dwordx4 v[116:119], v62, s[36:39], s57 offen
    s_add_u32 s57, s57, 32768
    buffer_load_dwordx4 v[120:123], v62, s[36:39], s57 offen
    s_add_u32 s57, s57, 32768
    buffer_load_dwordx4 v[124:127], v62, s[36:39], s57 offen
    s_add_u32 s57, s57, 32768
KF_AUXEND:
    s_nop 4
    s_lshr_b32 s56, s2, 3
    s_lshr_b32 s65, s56, 2
    s_and_b32 s66, s56, 3
    s_and_b32 s56, s2, 7
    s_lshl_b32 s56, s56, 2
    s_add_u32 s66, s66, s56
    s_lshl_b32 s68, s66, 6
    s_lshl_b32 s56, s64, 4
    s_add_u32 s68, s68, s56
    s_mul_i32 s67, s64, 24576
    v_and_b32 v232, 15, v2
    v_lshrrev_b32 v233, 2, v232
    v_lshlrev_b32 v233, 6, v233
    v_and_b32 v234, 3, v232
    v_lshl_add_u32 v239, v234, 3, v233
    s_lshr_b32 s59, s68, 5
    s_mul_i32 s59, s59, 64
    s_add_u32 s59, s59, 92160
    v_mov_b32 v5, 162072
    s_mov_b32 s70, 0
LW_70:
    s_nop 4
    ds_read_b32 v6, v5
    s_add_u32 s70, s70, 1
    s_waitcnt lgkmcnt(0)
    v_readfirstlane_b32 s71, v6
    s_cmp_gt_u32 s70, 262144
    s_cbranch_scc1 LWX_71
    s_cmp_ge_u32 s71, 40
    s_cbranch_scc1 LWX_71
    s_sleep 8
    s_branch LW_70
LWX_71:
    s_nop 4
    v_lshlrev_b32 v235, 4, v2
    s_mov_b32 s70, 0
    s_mov_b32 exec_lo, 0xf
    s_mov_b32 exec_hi, 0x0
POLL_72:
    s_nop 4
    buffer_load_dwordx2 v[232:233], v235, s[32:35], s59 offen sc1
    s_add_u32 s70, s70, 1
    s_waitcnt vmcnt(0)
    v_cmp_ne_u64 vcc, s[30:31], v[232:233]
    s_cmp_gt_u32 s70, 65536
    s_cbranch_scc1 POLLX_73
    s_cbranch_vccz POLLX_73
    s_sleep 4
    s_branch POLL_72
POLLX_73:
    s_nop 4
    s_mov_b64 exec, -1
    s_lshr_b32 s59, s68, 5
    s_lshl_b32 s59, s59, 8
    s_and_b32 s56, s68, 16
    s_lshl_b32 s56, s56, 1
    s_add_u32 s59, s59, s56
    s_add_u32 s59, s59, 133120
    buffer_load_dwordx2 v[232:233], v239, s[32:35], s59 offen sc1
    s_waitcnt vmcnt(0)
    v_mov_b32 v190, v232
    v_mov_b32 v191, v233
    v_mov_b32 v5, 162052
    s_mov_b32 s70, 0
LW_74:
    s_nop 4
    ds_read_b32 v6, v5
    s_add_u32 s70, s70, 1
    s_waitcnt lgkmcnt(0)
    v_readfirstlane_b32 s71, v6
    s_cmp_gt_u32 s70, 262144
    s_cbranch_scc1 LWX_75
    s_cmp_ge_u32 s71, 4
    s_cbranch_scc1 LWX_75
    s_sleep 2
    s_branch LW_74
LWX_75:
    s_nop 4
    s_lshr_b32 s56, s2, 3
    s_lshr_b32 s65, s56, 2
    s_and_b32 s66, s56, 3
    s_and_b32 s56, s2, 7
    s_lshl_b32 s56, s56, 2
    s_add_u32 s66, s66, s56
    s_lshl_b32 s68, s66, 6
    s_lshl_b32 s56, s64, 4
    s_add_u32 s68, s68, s56
    s_mul_i32 s67, s64, 24576
    s_add_u32 s63, s67, 8192
    s_mul_i32 s69, s68, 1280
    s_mul_i32 s56, s65, 160
    s_add_u32 s69, s69, s56
    s_mov_b32 s48, s4
    s_and_b32 s49, s5, 0xffff
    s_mov_b32 s50, 2621440
    s_mov_b32 s51, 0x00020000
    s_movk_i32 s56, 1280
    v_add_u32 v232, 0, v2
    v_mul_u32_u24 v233, 205, v232
    v_lshrrev_b32 v233, 11, v233
    v_mul_u32_u24 v234, 10, v233
    v_sub_u32 v234, v232, v234
    v_lshlrev_b32 v234, 4, v234
    v_mad_u32_u24 v236, v233, s56, v234
    s_add_u32 m0, s63, 0
    s_nop 0
    buffer_load_dwordx4 v236, s[48:51], s69 offen  lds
    v_add_u32 v232, 64, v2
    v_mul_u32_u24 v233, 205, v232
    v_lshrrev_b32 v233, 11, v233
    v_mul_u32_u24 v234, 10, v233
    v_sub_u32 v234, v232, v234
    v_lshlrev_b32 v234, 4, v234
    v_mad_u32_u24 v236, v233, s56, v234
    s_add_u32 m0, s63, 1024
    s_nop 0
    buffer_load_dwordx4 v236, s[48:51], s69 offen  lds
    v_add_u32 v232, 128, v2
    v_mul_u32_u24 v233, 205, v232
    v_lshrrev_b32 v233, 11, v233
    v_mul_u32_u24 v234, 10, v233
    v_sub_u32 v234, v232, v234
    v_lshlrev_b32 v234, 4, v234
    v_mad_u32_u24 v236, v233, s56, v234
    s_add_u32 m0, s63, 2048
    s_mov_b32 exec_lo, 0xffffffff
    s_mov_b32 exec_hi, 0x0
    buffer_load_dwordx4 v236, s[48:51], s69 offen  lds
    s_mov_b64 exec, -1
    v_and_b32 v232, 15, v2
    s_movk_i32 s56, 160
    v_mul_u32_u24 v240, s56, v232
    v_lshrrev_b32 v233, 4, v2
    v_lshl_add_u32 v240, v233, 3, v240
    v_add_u32 v240, s63, v240
    s_waitcnt vmcnt(0)
    ds_read_b64 v[242:243], v240 offset:0
    ds_read_b64 v[244:245], v240 offset:32
    ds_read_b64 v[246:247], v240 offset:64
    ds_read_b64 v[248:249], v240 offset:96
    ds_read_b64 v[250:251], v240 offset:128
    v_mov_b32 v232, v190
    v_mov_b32 v233, v191
    v_mov_b32 v5, 162084
    s_mov_b32 s70, 0
LW_76:
    s_nop 4
    ds_read_b32 v6, v5
    s_add_u32 s70, s70, 1
    s_waitcnt lgkmcnt(0)
    v_readfirstlane_b32 s71, v6
    s_cmp_gt_u32 s70, 262144
    s_cbranch_scc1 LWX_77
    s_cmp_ge_u32 s71, 4
    s_cbranch_scc1 LWX_77
    s_sleep 8
    s_branch LW_76
LWX_77:
    s_nop 4
    v_lshlrev_b32 v192, 16, v242
    v_and_b32 v193, 0xffff0000, v242
    v_lshlrev_b32 v194, 16, v243
    v_and_b32 v195, 0xffff0000, v243
    v_lshlrev_b32 v196, 16, v244
    v_and_b32 v197, 0xffff0000, v244
    v_lshlrev_b32 v198, 16, v245
    v_and_b32 v199, 0xffff0000, v245
    v_lshlrev_b32 v200, 16, v246
    v_and_b32 v201, 0xffff0000, v246
    v_lshlrev_b32 v202, 16, v247
    v_and_b32 v203, 0xffff0000, v247
    v_lshlrev_b32 v204, 16, v248
    v_and_b32 v205, 0xffff0000, v248
    v_lshlrev_b32 v206, 16, v249
    v_and_b32 v207, 0xffff0000, v249
    v_lshlrev_b32 v208, 16, v250
    v_and_b32 v209, 0xffff0000, v250
    v_lshlrev_b32 v210, 16, v251
    v_and_b32 v211, 0xffff0000, v251
    v_sub_f32 v212, v192, v232
    v_sub_f32 v213, v193, v232
    v_sub_f32 v214, v194, v232
    v_sub_f32 v215, v195, v232
    v_sub_f32 v216, v196, v232
    v_sub_f32 v217, v197, v232
    v_sub_f32 v218, v198, v232
    v_sub_f32 v219, v199, v232
    v_sub_f32 v220, v200, v232
    v_sub_f32 v221, v201, v232
    v_sub_f32 v222, v202, v232
    v_sub_f32 v223, v203, v232
    v_sub_f32 v224, v204, v232
    v_sub_f32 v225, v205, v232
    v_sub_f32 v226, v206, v232
    v_sub_f32 v227, v207, v232
    v_sub_f32 v228, v208, v232
    v_sub_f32 v229, v209, v232
    v_sub_f32 v230, v210, v232
    v_sub_f32 v231, v211, v232
    v_cvt_pk_bf16_f32 v242, v212, v213
    v_cvt_pk_bf16_f32 v243, v214, v215
    v_cvt_pk_bf16_f32 v244, v216, v217
    v_cvt_pk_bf16_f32 v245, v218, v219
    v_cvt_pk_bf16_f32 v246, v220, v221
    v_cvt_pk_bf16_f32 v247, v222, v223
    v_cvt_pk_bf16_f32 v248, v224, v225
    v_cvt_pk_bf16_f32 v249, v226, v227
    v_cvt_pk_bf16_f32 v250, v228, v229
    v_cvt_pk_bf16_f32 v251, v230, v231
    v_lshlrev_b32 v212, 16, v242
    v_and_b32 v213, 0xffff0000, v242
    v_lshlrev_b32 v214, 16, v243
    v_and_b32 v215, 0xffff0000, v243
    v_lshlrev_b32 v216, 16, v244
    v_and_b32 v217, 0xffff0000, v244
    v_lshlrev_b32 v218, 16, v245
    v_and_b32 v219, 0xffff0000, v245
    v_lshlrev_b32 v220, 16, v246
    v_and_b32 v221, 0xffff0000, v246
    v_lshlrev_b32 v222, 16, v247
    v_and_b32 v223, 0xffff0000, v247
    v_lshlrev_b32 v224, 16, v248
    v_and_b32 v225, 0xffff0000, v248
    v_lshlrev_b32 v226, 16, v249
    v_and_b32 v227, 0xffff0000, v249
    v_lshlrev_b32 v228, 16, v250
    v_and_b32 v229, 0xffff0000, v250
    v_lshlrev_b32 v230, 16, v251
    v_and_b32 v231, 0xffff0000, v251
    v_mul_f32 v212, v212, v233
    v_mul_f32 v213, v213, v233
    v_mul_f32 v214, v214, v233
    v_mul_f32 v215, v215, v233
    v_mul_f32 v216, v216, v233
    v_mul_f32 v217, v217, v233
    v_mul_f32 v218, v218, v233
    v_mul_f32 v219, v219, v233
    v_mul_f32 v220, v220, v233
    v_mul_f32 v221, v221, v233
    v_mul_f32 v222, v222, v233
    v_mul_f32 v223, v223, v233
    v_mul_f32 v224, v224, v233
    v_mul_f32 v225, v225, v233
    v_mul_f32 v226, v226, v233
    v_mul_f32 v227, v227, v233
    v_mul_f32 v228, v228, v233
    v_mul_f32 v229, v229, v233
    v_mul_f32 v230, v230, v233
    v_mul_f32 v231, v231, v233
    v_cvt_pk_bf16_f32 v242, v212, v213
    v_cvt_pk_bf16_f32 v243, v214, v215
    v_cvt_pk_bf16_f32 v244, v216, v217
    v_cvt_pk_bf16_f32 v245, v218, v219
    v_cvt_pk_bf16_f32 v246, v220, v221
    v_cvt_pk_bf16_f32 v247, v222, v223
    v_cvt_pk_bf16_f32 v248, v224, v225
    v_cvt_pk_bf16_f32 v249, v226, v227
    v_cvt_pk_bf16_f32 v250, v228, v229
    v_cvt_pk_bf16_f32 v251, v230, v231
    v_lshlrev_b32 v212, 16, v242
    v_and_b32 v213, 0xffff0000, v242
    v_lshlrev_b32 v214, 16, v243
    v_and_b32 v215, 0xffff0000, v243
    v_lshlrev_b32 v216, 16, v244
    v_and_b32 v217, 0xffff0000, v244
    v_lshlrev_b32 v218, 16, v245
    v_and_b32 v219, 0xffff0000, v245
    v_lshlrev_b32 v220, 16, v246
    v_and_b32 v221, 0xffff0000, v246
    v_lshlrev_b32 v222, 16, v247
    v_and_b32 v223, 0xffff0000, v247
    v_lshlrev_b32 v224, 16, v248
    v_and_b32 v225, 0xffff0000, v248
    v_lshlrev_b32 v226, 16, v249
    v_and_b32 v227, 0xffff0000, v249
    v_lshlrev_b32 v228, 16, v250
    v_and_b32 v229, 0xffff0000, v250
    v_lshlrev_b32 v230, 16, v251
    v_and_b32 v231, 0xffff0000, v251
KF_P2:
    s_nop 4
    v_bfe_u32 v32, v2, 1, 2
    v_lshrrev_b32 v33, 4, v2
    v_xor_b32 v32, v32, v33
    v_lshlrev_b32 v32, 5, v32
    v_and_b32 v33, 1, v2
    v_lshl_add_u32 v32, v33, 4, v32
    v_lshrrev_b32 v33, 3, v2
    v_lshl_add_u32 v32, v33, 12, v32
    s_mul_i32 s57, s65, 80
    s_mul_i32 s56, s64, 24
    s_add_u32 s57, s57, s56
    s_mul_i32 s59, s57, 16
    s_add_u32 s59, s59, 81920
    s_lshl_b32 s57, s57, 12
    s_lshl_b32 s56, s66, 7
    s_add_u32 s57, s57, s56
    s_add_u32 s57, s57, 5439488
    s_mul_i32 s58, s64, 4608
    s_add_u32 s58, s58, 148352
    v_bfe_u32 v34, v2, 3, 2
    v_xor_b32 v34, s64, v34
    v_lshlrev_b32 v34, 5, v34
    v_and_b32 v35, 3, v2
    v_lshl_add_u32 v34, v35, 3, v34
    v_add_u32 v34, 148352, v34
    v_lshrrev_b32 v35, 2, v2
    s_movk_i32 s56, 1536
    v_add_u32 v36, 0, v35
    v_mul_u32_u24 v37, 43, v36
    v_lshrrev_b32 v37, 10, v37
    v_lshl_add_u32 v36, v36, 7, v34
    v_mad_u32_u24 v40, v37, s56, v36
    v_add_u32 v36, 16, v35
    v_mul_u32_u24 v37, 43, v36
    v_lshrrev_b32 v37, 10, v37
    v_lshl_add_u32 v36, v36, 7, v34
    v_mad_u32_u24 v41, v37, s56, v36
    v_add_u32 v36, 32, v35
    v_mul_u32_u24 v37, 43, v36
    v_lshrrev_b32 v37, 10, v37
    v_lshl_add_u32 v36, v36, 7, v34
    v_mad_u32_u24 v42, v37, s56, v36
    v_add_u32 v36, 48, v35
    v_mul_u32_u24 v37, 43, v36
    v_lshrrev_b32 v37, 10, v37
    v_lshl_add_u32 v36, v36, 7, v34
    v_mad_u32_u24 v43, v37, s56, v36
    v_add_u32 v36, 64, v35
    v_mul_u32_u24 v37, 43, v36
    v_lshrrev_b32 v37, 10, v37
    v_lshl_add_u32 v36, v36, 7, v34
    v_mad_u32_u24 v44, v37, s56, v36
    v_lshlrev_b32 v38, 3, v2
    v_add_u32 v38, s67, v38
    v_mov_b32 v5, 162052
    s_mov_b32 s70, 0
LW_78:
    s_nop 4
    ds_read_b32 v6, v5
    s_add_u32 s70, s70, 1
    s_waitcnt lgkmcnt(0)
    v_readfirstlane_b32 s71, v6
    s_cmp_gt_u32 s70, 262144
    s_cbranch_scc1 LWX_79
    s_cmp_ge_u32 s71, 4
    s_cbranch_scc1 LWX_79
    s_sleep 8
    s_branch LW_78
LWX_79:
    s_nop 4
    v_mov_b32 v5, 162096
    s_mov_b32 s70, 0
LW_80:
    s_nop 4
    ds_read_b32 v6, v5
    s_add_u32 s70, s70, 1
    s_waitcnt lgkmcnt(0)
    v_readfirstlane_b32 s71, v6
    s_cmp_gt_u32 s70, 262144
    s_cbranch_scc1 LWX_81
    s_cmp_ge_u32 s71, 1
    s_cbranch_scc1 LWX_81
    s_sleep 8
    s_branch LW_80
LWX_81:
    s_nop 4
    v_lshlrev_b32 v39, 4, v2
    s_cmp_eq_u32 s64, 3
    s_cbranch_scc1 Z8_82
    s_mov_b32 s70, 0
    s_mov_b32 exec_lo, 0xffffff
    s_mov_b32 exec_hi, 0x0
POLL_84:
    s_nop 4
    buffer_load_dwordx2 v[46:47], v39, s[32:35], s59 offen sc1
    s_add_u32 s70, s70, 1
    s_waitcnt vmcnt(0)
    v_cmp_ne_u64 vcc, s[30:31], v[46:47]
    s_cmp_gt_u32 s70, 65536
    s_cbranch_scc1 POLLX_85
    s_cbranch_vccz POLLX_85
    s_sleep 4
    s_branch POLL_84
POLLX_85:
    s_nop 4
    s_mov_b64 exec, -1
    s_add_u32 m0, s58, 0
    s_nop 0
    buffer_load_dwordx4 v32, s[32:35], s57 offen sc1 lds
    s_add_u32 s57, s57, 32768
    s_add_u32 m0, s58, 1024
    s_nop 0
    buffer_load_dwordx4 v32, s[32:35], s57 offen sc1 lds
    s_add_u32 s57, s57, 32768
    s_add_u32 m0, s58, 2048
    s_nop 0
    buffer_load_dwordx4 v32, s[32:35], s57 offen sc1 lds
    s_add_u32 s57, s57, 32768
    s_branch ZJ_83
Z8_82:
    s_nop 4
    s_mov_b32 s70, 0
    s_mov_b32 exec_lo, 0xff
    s_mov_b32 exec_hi, 0x0
POLL_86:
    s_nop 4
    buffer_load_dwordx2 v[46:47], v39, s[32:35], s59 offen sc1
    s_add_u32 s70, s70, 1
    s_waitcnt vmcnt(0)
    v_cmp_ne_u64 vcc, s[30:31], v[46:47]
    s_cmp_gt_u32 s70, 65536
    s_cbranch_scc1 POLLX_87
    s_cbranch_vccz POLLX_87
    s_sleep 4
    s_branch POLL_86
POLLX_87:
    s_nop 4
    s_mov_b64 exec, -1
    s_mov_b32 m0, s58
    s_nop 0
    buffer_load_dwordx4 v32, s[32:35], s57 offen sc1 lds
ZJ_83:
    s_nop 4
    s_waitcnt vmcnt(0)
    v_mov_b32 v5, 162088
    v_mov_b32 v6, 1
    s_waitcnt lgkmcnt(0)
    s_mov_b64 exec, 1
    ds_add_u32 v5, v6
    s_mov_b64 exec, -1
    v_mov_b32 v5, 162088
    s_mov_b32 s70, 0
LW_88:
    s_nop 4
    ds_read_b32 v6, v5
    s_add_u32 s70, s70, 1
    s_waitcnt lgkmcnt(0)
    v_readfirstlane_b32 s71, v6
    s_cmp_gt_u32 s70, 262144
    s_cbranch_scc1 LWX_89
    s_cmp_ge_u32 s71, 4
    s_cbranch_scc1 LWX_89
    s_sleep 1
    s_branch LW_88
LWX_89:
    s_nop 4
    ds_read_b64_tr_b16 v[48:49], v40
    ds_read_b64_tr_b16 v[50:51], v41
    ds_read_b64_tr_b16 v[52:53], v42
    ds_read_b64_tr_b16 v[54:55], v43
    ds_read_b64_tr_b16 v[56:57], v44
    s_waitcnt lgkmcnt(0)
    v_lshlrev_b32 v64, 16, v48
    v_and_b32 v65, 0xffff0000, v48
    v_lshlrev_b32 v66, 16, v49
    v_and_b32 v67, 0xffff0000, v49
    v_lshlrev_b32 v68, 16, v50
    v_and_b32 v69, 0xffff0000, v50
    v_lshlrev_b32 v70, 16, v51
    v_and_b32 v71, 0xffff0000, v51
    v_lshlrev_b32 v72, 16, v52
    v_and_b32 v73, 0xffff0000, v52
    v_lshlrev_b32 v74, 16, v53
    v_and_b32 v75, 0xffff0000, v53
    v_lshlrev_b32 v76, 16, v54
    v_and_b32 v77, 0xffff0000, v54
    v_lshlrev_b32 v78, 16, v55
    v_and_b32 v79, 0xffff0000, v55
    v_lshlrev_b32 v80, 16, v56
    v_and_b32 v81, 0xffff0000, v56
    v_lshlrev_b32 v82, 16, v57
    v_and_b32 v83, 0xffff0000, v57
    v_mul_f32 v64, v64, v212
    v_mul_f32 v65, v65, v213
    v_mul_f32 v66, v66, v214
    v_mul_f32 v67, v67, v215
    v_mul_f32 v68, v68, v216
    v_mul_f32 v69, v69, v217
    v_mul_f32 v70, v70, v218
    v_mul_f32 v71, v71, v219
    v_mul_f32 v72, v72, v220
    v_mul_f32 v73, v73, v221
    v_mul_f32 v74, v74, v222
    v_mul_f32 v75, v75, v223
    v_mul_f32 v76, v76, v224
    v_mul_f32 v77, v77, v225
    v_mul_f32 v78, v78, v226
    v_mul_f32 v79, v79, v227
    v_mul_f32 v80, v80, v228
    v_mul_f32 v81, v81, v229
    v_mul_f32 v82, v82, v230
    v_mul_f32 v83, v83, v231
    v_cvt_pk_bf16_f32 v48, v64, v65
    v_cvt_pk_bf16_f32 v49, v66, v67
    v_cvt_pk_bf16_f32 v50, v68, v69
    v_cvt_pk_bf16_f32 v51, v70, v71
    v_cvt_pk_bf16_f32 v52, v72, v73
    v_cvt_pk_bf16_f32 v53, v74, v75
    v_cvt_pk_bf16_f32 v54, v76, v77
    v_cvt_pk_bf16_f32 v55, v78, v79
    v_cvt_pk_bf16_f32 v56, v80, v81
    v_cvt_pk_bf16_f32 v57, v82, v83
    v_lshlrev_b32 v64, 16, v48
    v_and_b32 v65, 0xffff0000, v48
    v_lshlrev_b32 v66, 16, v49
    v_and_b32 v67, 0xffff0000, v49
    v_lshlrev_b32 v68, 16, v50
    v_and_b32 v69, 0xffff0000, v50
    v_lshlrev_b32 v70, 16, v51
    v_and_b32 v71, 0xffff0000, v51
    v_lshlrev_b32 v72, 16, v52
    v_and_b32 v73, 0xffff0000, v52
    v_lshlrev_b32 v74, 16, v53
    v_and_b32 v75, 0xffff0000, v53
    v_lshlrev_b32 v76, 16, v54
    v_and_b32 v77, 0xffff0000, v54
    v_lshlrev_b32 v78, 16, v55
    v_and_b32 v79, 0xffff0000, v55
    v_lshlrev_b32 v80, 16, v56
    v_and_b32 v81, 0xffff0000, v56
    v_lshlrev_b32 v82, 16, v57
    v_and_b32 v83, 0xffff0000, v57
    v_add_f32 v64, v64, v192
    v_add_f32 v65, v65, v193
    v_add_f32 v66, v66, v194
    v_add_f32 v67, v67, v195
    v_add_f32 v68, v68, v196
    v_add_f32 v69, v69, v197
    v_add_f32 v70, v70, v198
    v_add_f32 v71, v71, v199
    v_add_f32 v72, v72, v200
    v_add_f32 v73, v73, v201
    v_add_f32 v74, v74, v202
    v_add_f32 v75, v75, v203
    v_add_f32 v76, v76, v204
    v_add_f32 v77, v77, v205
    v_add_f32 v78, v78, v206
    v_add_f32 v79, v79, v207
    v_add_f32 v80, v80, v208
    v_add_f32 v81, v81, v209
    v_add_f32 v82, v82, v210
    v_add_f32 v83, v83, v211
    v_cvt_pk_bf16_f32 v48, v64, v65
    v_cvt_pk_bf16_f32 v49, v66, v67
    v_cvt_pk_bf16_f32 v50, v68, v69
    v_cvt_pk_bf16_f32 v51, v70, v71
    v_cvt_pk_bf16_f32 v52, v72, v73
    v_cvt_pk_bf16_f32 v53, v74, v75
    v_cvt_pk_bf16_f32 v54, v76, v77
    v_cvt_pk_bf16_f32 v55, v78, v79
    v_cvt_pk_bf16_f32 v56, v80, v81
    v_cvt_pk_bf16_f32 v57, v82, v83
    ds_write_b64 v38, v[48:49] offset:8192
    ds_write_b64 v38, v[50:51] offset:8704
    ds_write_b64 v38, v[52:53] offset:9216
    ds_write_b64 v38, v[54:55] offset:9728
    ds_write_b64 v38, v[56:57] offset:10240
    v_mov_b32 v5, 162092
    v_mov_b32 v6, 1
    s_waitcnt lgkmcnt(0)
    s_mov_b64 exec, 1
    ds_add_u32 v5, v6
    s_mov_b64 exec, -1
KF_DONE:
    s_nop 4
    s_endpgm
CODE_END:
.section .rodata,"a"
.p2align 6
.amdhsa_kernel parallel_sum__ssm_conv_h3__mixer_token_mlp__prompt_kernel
  .amdhsa_next_free_vgpr 256
  .amdhsa_next_free_sgpr 72
  .amdhsa_accum_offset 256
  .amdhsa_group_segment_fixed_size 0
  .amdhsa_kernarg_size 112
  .amdhsa_user_sgpr_count 2
  .amdhsa_user_sgpr_kernarg_segment_ptr 1
  .amdhsa_system_sgpr_workgroup_id_x 1
  .amdhsa_float_denorm_mode_32 3
  .amdhsa_float_denorm_mode_16_64 3
.end_amdhsa_kernel
```
